```python
import torch

def _softmax(x, axis=-1):
    return torch.softmax(x, dim=axis)
def _gelu(x):
    return torch.nn.functional.gelu(x, approximate="tanh")
def _silu(x):
    return torch.nn.functional.silu(x)
def _sigmoid(x):
    return torch.sigmoid(x)
def _layernorm(x, axis=-1, eps=1e-5):
    m = x.mean(dim=axis, keepdim=True)
    v = x.var(dim=axis, keepdim=True, unbiased=False)
    return (x - m) / torch.sqrt(v + eps)
def _scatter_add(tgt, idx, src, axis=0):
    return tgt.clone().index_add_(axis, idx, src)
def _segment_sum(src, seg, n):
    out = torch.zeros((n,) + src.shape[1:], dtype=src.dtype)
    return out.index_add_(0, seg, src)
def _pad(x, pw):
    flat = tuple(v for pair in reversed(pw) for v in pair)
    return torch.nn.functional.pad(x, flat)

kernel_name = 'concat_heads__sliding_block__spectral_fnet__prompt'

def setup_inputs():

    _w = (lambda a: (lambda t: t.to(torch.bfloat16) if t.is_floating_point() else t)(torch.as_tensor(a)))
    def _A_setup():
        B, S, D = 1, 2048, 640
        return {
            "x": _w((lambda *s: torch.randn(*s, dtype=torch.bfloat16) * 0.2)(B, S, D)),
            "wqkv": _w((lambda *s: torch.randn(*s, dtype=torch.bfloat16) * 0.8)(D, 3 * D)),
            "wo": _w((lambda *s: torch.randn(*s, dtype=torch.bfloat16) * 0.2)(D, D)),
        }
    _A_in = _A_setup()

    def _B_setup():
        B, S, D = 1, 2048, 640
        ns = torch.arange(S)[:, None] * torch.arange(S)[None, :]
        nd = torch.arange(D)[:, None] * torch.arange(D)[None, :]
        Ws_re = torch.cos(-2.0 * torch.pi * ns / S).to(float)
        Ws_im = torch.sin(-2.0 * torch.pi * ns / S).to(float)
        Wd_re = torch.cos(-2.0 * torch.pi * nd / D).to(float)
        Wd_im = torch.sin(-2.0 * torch.pi * nd / D).to(float)
        return {
            "x": _w((lambda *s: torch.randn(*s, dtype=torch.bfloat16) * 0.05)(B, S, D)),
            "dft_seq_re": _w(Ws_re),
            "dft_seq_im": _w(Ws_im),
            "dft_hid_re": _w(Wd_re),
            "dft_hid_im": _w(Wd_im),
        }
    _B_in = _B_setup()

    return {
        "A_x": _A_in["x"],
        "A_wqkv": _A_in["wqkv"],
        "A_wo": _A_in["wo"],
        "B_x": _B_in["x"],
        "B_dft_seq_re": _B_in["dft_seq_re"],
        "B_dft_seq_im": _B_in["dft_seq_im"],
        "B_dft_hid_re": _B_in["dft_hid_re"],
        "B_dft_hid_im": _B_in["dft_hid_im"],
    }

def reference(A_x, A_wqkv, A_wo, B_x, B_dft_seq_re, B_dft_seq_im, B_dft_hid_re, B_dft_hid_im):
    def _A_ref(x, wqkv, wo):
        B, S, D = x.shape
        H = 32; Dh = D // H; W = 256
        qkv = (lambda x, *d: x.permute(*d))((x @ wqkv).reshape(B, S, 3, H, Dh), 2, 0, 3, 1, 4)
        q, k, v = qkv[0], qkv[1], qkv[2]
        scores = torch.einsum("bhqd,bhkd->bhqk", q, k) * (Dh ** -0.5)
        idx = torch.arange(S)
        mask = (idx[:, None] - idx[None, :] >= 0) & (idx[:, None] - idx[None, :] < W)
        scores = torch.where(mask[None, None], scores, -1e9)
        p = _softmax(scores, axis=-1)
        o = torch.einsum("bhqk,bhkd->bhqd", p, v)
        return (lambda x, *d: x.permute(*d))(o, 0, 2, 1, 3).reshape(B, S, D) @ wo

    def _B_ref(x, dft_seq_re, dft_seq_im, dft_hid_re, dft_hid_im):
        a = torch.einsum("bsd,ed->bse", x, dft_hid_re)
        b = torch.einsum("bsd,ed->bse", x, dft_hid_im)
        y = torch.einsum("ts,bse->bte", dft_seq_re, a) - torch.einsum("ts,bse->bte", dft_seq_im, b)
        return y

    a = _A_ref(A_x, A_wqkv, A_wo)
    b = _B_ref(B_x, B_dft_seq_re, B_dft_seq_im, B_dft_hid_re, B_dft_hid_im)
    return torch.concatenate([a, b], axis=-1)
```

```asm
; @launch grid=(256,1,1) block=(512,1,1) lds=163840
.amdgcn_target "amdgcn-amd-amdhsa--gfx950"
.text
.globl concat_heads__sliding_block__spectral_fnet__prompt_kernel
.p2align 8
.type concat_heads__sliding_block__spectral_fnet__prompt_kernel,@function
concat_heads__sliding_block__spectral_fnet__prompt_kernel:
    s_cmp_ge_u32 s2, 256
    s_cbranch_scc1 L_end_1
    s_load_dwordx16 s[4:19], s[0:1], 0
    s_load_dwordx4 s[20:23], s[0:1], 64
    s_load_dwordx2 s[24:25], s[0:1], 80
    v_lshrrev_b32 v2, 6, v0
    v_and_b32 v1, 63, v0
    v_readfirstlane_b32 s46, v2
    s_and_b32 s44, s2, 7
    s_lshr_b32 s45, s2, 3
    s_cmp_ge_u32 s45, 15
    s_cselect_b32 s47, 1, 0
    s_cselect_b32 s48, 15, 0
    s_lshl_b32 s98, s44, 1
    s_add_u32 s98, s98, s47
    s_sub_u32 s99, s45, s48
    s_cmp_lt_u32 s46, 4
    s_cbranch_scc1 L_low_2
    s_cmp_ge_u32 s45, 30
    s_cbranch_scc1 L_spare_3
    s_sub_u32 s50, s46, 4
    s_lshl_b32 s49, s50, 12
    v_lshrrev_b32 v8, 3, v1
    s_lshl_b32 s48, s98, 2
    s_add_u32 s48, s48, s50
    s_mul_i32 s48, s48, 40960
    v_mul_u32_u24 v8, 1280, v8
    v_add_u32 v8, s48, v8
    v_lshrrev_b32 v9, 4, v1
    v_and_b32 v2, 7, v1
    v_xor_b32 v2, v2, v9
    v_xor_b32 v3, 4, v2
    v_lshl_add_u32 v2, v2, 4, v8
    v_lshl_add_u32 v3, v3, 4, v8
    s_mul_i32 s48, s50, 61440
    s_lshl_b32 s47, s99, 8
    s_add_u32 s48, s48, s47
    v_mul_u32_u24 v8, 3840, v9
    v_add_u32 v8, s48, v8
    v_lshlrev_b32 v9, 1, v9
    v_and_b32 v4, 15, v1
    v_xor_b32 v4, v4, v9
    v_xor_b32 v5, 8, v4
    v_lshl_add_u32 v4, v4, 4, v8
    v_lshl_add_u32 v5, v5, 4, v8
    s_waitcnt lgkmcnt(0)
    s_mov_b32 s28, s4
    s_mov_b32 s29, s5
    s_mov_b32 s30, 2621440
    s_mov_b32 s31, 0x20000
    s_mov_b32 s32, s6
    s_mov_b32 s33, s7
    s_mov_b32 s34, 2457600
    s_mov_b32 s35, 0x20000
    s_cmp_ge_u32 s50, 2
    s_cbranch_scc1 L_bw_10
    s_lshl_b32 s47, s45, 1
    s_add_u32 s47, s47, s50
    s_mul_i32 s47, s47, 5504
    s_mul_i32 s48, s44, 327680
    s_add_u32 s47, s47, s48
    v_min_u32 v8, 42, v1
    v_lshlrev_b32 v8, 7, v8
    buffer_load_dword v16, v8, s[28:31], s47 offen
    s_branch L_bj_11
L_bw_10:
    s_lshl_b32 s47, s2, 1
    s_add_u32 s47, s47, s50
    s_sub_u32 s47, s47, 2
    s_mul_i32 s47, s47, 5120
    v_min_u32 v8, 39, v1
    v_lshlrev_b32 v8, 7, v8
    buffer_load_dword v20, v8, s[32:35], s47 offen
L_bj_11:
    s_add_u32 m0, s49, 0
    s_mov_b32 s47, 0
    buffer_load_dwordx4 v2, s[28:31], s47 offen  lds
    s_add_u32 m0, s49, 16384
    s_mov_b32 s47, 0
    buffer_load_dwordx4 v4, s[32:35], s47 offen  lds
    s_add_u32 m0, s49, 1024
    s_mov_b32 s47, 10240
    buffer_load_dwordx4 v3, s[28:31], s47 offen  lds
    s_add_u32 m0, s49, 17408
    s_mov_b32 s47, 15360
    buffer_load_dwordx4 v4, s[32:35], s47 offen  lds
    s_add_u32 m0, s49, 2048
    s_mov_b32 s47, 20480
    buffer_load_dwordx4 v2, s[28:31], s47 offen  lds
    s_add_u32 m0, s49, 18432
    s_mov_b32 s47, 30720
    buffer_load_dwordx4 v5, s[32:35], s47 offen  lds
    s_add_u32 m0, s49, 3072
    s_mov_b32 s47, 30720
    buffer_load_dwordx4 v3, s[28:31], s47 offen  lds
    s_add_u32 m0, s49, 19456
    s_mov_b32 s47, 46080
    buffer_load_dwordx4 v5, s[32:35], s47 offen  lds
    s_add_u32 m0, s49, 32768
    s_mov_b32 s47, 128
    buffer_load_dwordx4 v2, s[28:31], s47 offen  lds
    s_add_u32 m0, s49, 49152
    s_mov_b32 s47, 245760
    buffer_load_dwordx4 v4, s[32:35], s47 offen  lds
    s_add_u32 m0, s49, 33792
    s_mov_b32 s47, 10368
    buffer_load_dwordx4 v3, s[28:31], s47 offen  lds
    s_add_u32 m0, s49, 50176
    s_mov_b32 s47, 261120
    buffer_load_dwordx4 v4, s[32:35], s47 offen  lds
    s_add_u32 m0, s49, 34816
    s_mov_b32 s47, 20608
    buffer_load_dwordx4 v2, s[28:31], s47 offen  lds
    s_add_u32 m0, s49, 51200
    s_mov_b32 s47, 276480
    buffer_load_dwordx4 v5, s[32:35], s47 offen  lds
    s_add_u32 m0, s49, 35840
    s_mov_b32 s47, 30848
    buffer_load_dwordx4 v3, s[28:31], s47 offen  lds
    s_add_u32 m0, s49, 52224
    s_mov_b32 s47, 291840
    buffer_load_dwordx4 v5, s[32:35], s47 offen  lds
    s_mov_b32 s36, s24
    s_mov_b32 s37, s25
    s_mov_b32 s38, 16777216
    s_mov_b32 s39, 0x20000
    s_mov_b32 s47, 14811136
    s_load_dword s26, s[36:37], s47
    s_waitcnt vmcnt(8)
    s_barrier
    s_add_u32 m0, s49, 65536
    s_mov_b32 s47, 256
    buffer_load_dwordx4 v2, s[28:31], s47 offen  lds
    s_add_u32 m0, s49, 81920
    s_mov_b32 s47, 491520
    buffer_load_dwordx4 v4, s[32:35], s47 offen  lds
    s_add_u32 m0, s49, 66560
    s_mov_b32 s47, 10496
    buffer_load_dwordx4 v3, s[28:31], s47 offen  lds
    s_add_u32 m0, s49, 82944
    s_mov_b32 s47, 506880
    buffer_load_dwordx4 v4, s[32:35], s47 offen  lds
    s_add_u32 m0, s49, 67584
    s_mov_b32 s47, 20736
    buffer_load_dwordx4 v2, s[28:31], s47 offen  lds
    s_add_u32 m0, s49, 83968
    s_mov_b32 s47, 522240
    buffer_load_dwordx4 v5, s[32:35], s47 offen  lds
    s_add_u32 m0, s49, 68608
    s_mov_b32 s47, 30976
    buffer_load_dwordx4 v3, s[28:31], s47 offen  lds
    s_add_u32 m0, s49, 84992
    s_mov_b32 s47, 537600
    buffer_load_dwordx4 v5, s[32:35], s47 offen  lds
    s_add_u32 m0, s49, 98304
    s_mov_b32 s47, 384
    buffer_load_dwordx4 v2, s[28:31], s47 offen  lds
    s_add_u32 m0, s49, 114688
    s_mov_b32 s47, 737280
    buffer_load_dwordx4 v4, s[32:35], s47 offen  lds
    s_add_u32 m0, s49, 99328
    s_mov_b32 s47, 10624
    buffer_load_dwordx4 v3, s[28:31], s47 offen  lds
    s_add_u32 m0, s49, 115712
    s_mov_b32 s47, 752640
    buffer_load_dwordx4 v4, s[32:35], s47 offen  lds
    s_add_u32 m0, s49, 100352
    s_mov_b32 s47, 20864
    buffer_load_dwordx4 v2, s[28:31], s47 offen  lds
    s_add_u32 m0, s49, 116736
    s_mov_b32 s47, 768000
    buffer_load_dwordx4 v5, s[32:35], s47 offen  lds
    s_add_u32 m0, s49, 101376
    s_mov_b32 s47, 31104
    buffer_load_dwordx4 v3, s[28:31], s47 offen  lds
    s_add_u32 m0, s49, 117760
    s_mov_b32 s47, 783360
    buffer_load_dwordx4 v5, s[32:35], s47 offen  lds
    s_waitcnt vmcnt(16)
    s_barrier
    s_add_u32 m0, s49, 0
    s_mov_b32 s47, 512
    buffer_load_dwordx4 v2, s[28:31], s47 offen  lds
    s_add_u32 m0, s49, 16384
    s_mov_b32 s47, 983040
    buffer_load_dwordx4 v4, s[32:35], s47 offen  lds
    s_add_u32 m0, s49, 1024
    s_mov_b32 s47, 10752
    buffer_load_dwordx4 v3, s[28:31], s47 offen  lds
    s_add_u32 m0, s49, 17408
    s_mov_b32 s47, 998400
    buffer_load_dwordx4 v4, s[32:35], s47 offen  lds
    s_add_u32 m0, s49, 2048
    s_mov_b32 s47, 20992
    buffer_load_dwordx4 v2, s[28:31], s47 offen  lds
    s_add_u32 m0, s49, 18432
    s_mov_b32 s47, 1013760
    buffer_load_dwordx4 v5, s[32:35], s47 offen  lds
    s_add_u32 m0, s49, 3072
    s_mov_b32 s47, 31232
    buffer_load_dwordx4 v3, s[28:31], s47 offen  lds
    s_add_u32 m0, s49, 19456
    s_mov_b32 s47, 1029120
    buffer_load_dwordx4 v5, s[32:35], s47 offen  lds
    s_waitcnt lgkmcnt(0)
    s_mul_i32 s26, s26, 1664525
    s_add_u32 s26, s26, 1013904223
    s_waitcnt vmcnt(16)
    s_barrier
    s_add_u32 m0, s49, 32768
    s_mov_b32 s47, 640
    buffer_load_dwordx4 v2, s[28:31], s47 offen  lds
    s_add_u32 m0, s49, 49152
    s_mov_b32 s47, 1228800
    buffer_load_dwordx4 v4, s[32:35], s47 offen  lds
    s_add_u32 m0, s49, 33792
    s_mov_b32 s47, 10880
    buffer_load_dwordx4 v3, s[28:31], s47 offen  lds
    s_add_u32 m0, s49, 50176
    s_mov_b32 s47, 1244160
    buffer_load_dwordx4 v4, s[32:35], s47 offen  lds
    s_add_u32 m0, s49, 34816
    s_mov_b32 s47, 21120
    buffer_load_dwordx4 v2, s[28:31], s47 offen  lds
    s_add_u32 m0, s49, 51200
    s_mov_b32 s47, 1259520
    buffer_load_dwordx4 v5, s[32:35], s47 offen  lds
    s_add_u32 m0, s49, 35840
    s_mov_b32 s47, 31360
    buffer_load_dwordx4 v3, s[28:31], s47 offen  lds
    s_add_u32 m0, s49, 52224
    s_mov_b32 s47, 1274880
    buffer_load_dwordx4 v5, s[32:35], s47 offen  lds
    s_getreg_b32 s48, hwreg(HW_REG_XCC_ID, 0, 4)
    s_add_u32 s48, s48, s26
    s_add_u32 s48, s48, 1
    s_lshl_b32 s47, s2, 7
    s_add_u32 s47, s47, 14778368
    s_cmp_eq_u32 s46, 4
    s_cselect_b32 s47, s47, 16777216
    v_mov_b32 v17, s47
    v_mov_b32 v18, s48
    s_mov_b64 exec, 1
    buffer_store_dword v18, v17, s[36:39], 0 offen sc1
    s_mov_b64 exec, -1
    s_waitcnt vmcnt(16)
    s_barrier
    s_add_u32 m0, s49, 65536
    s_mov_b32 s47, 768
    buffer_load_dwordx4 v2, s[28:31], s47 offen  lds
    s_add_u32 m0, s49, 81920
    s_mov_b32 s47, 1474560
    buffer_load_dwordx4 v4, s[32:35], s47 offen  lds
    s_add_u32 m0, s49, 66560
    s_mov_b32 s47, 11008
    buffer_load_dwordx4 v3, s[28:31], s47 offen  lds
    s_add_u32 m0, s49, 82944
    s_mov_b32 s47, 1489920
    buffer_load_dwordx4 v4, s[32:35], s47 offen  lds
    s_add_u32 m0, s49, 67584
    s_mov_b32 s47, 21248
    buffer_load_dwordx4 v2, s[28:31], s47 offen  lds
    s_add_u32 m0, s49, 83968
    s_mov_b32 s47, 1505280
    buffer_load_dwordx4 v5, s[32:35], s47 offen  lds
    s_add_u32 m0, s49, 68608
    s_mov_b32 s47, 31488
    buffer_load_dwordx4 v3, s[28:31], s47 offen  lds
    s_add_u32 m0, s49, 84992
    s_mov_b32 s47, 1520640
    buffer_load_dwordx4 v5, s[32:35], s47 offen  lds
    s_waitcnt vmcnt(16)
    s_barrier
    s_add_u32 m0, s49, 98304
    s_mov_b32 s47, 896
    buffer_load_dwordx4 v2, s[28:31], s47 offen  lds
    s_add_u32 m0, s49, 114688
    s_mov_b32 s47, 1720320
    buffer_load_dwordx4 v4, s[32:35], s47 offen  lds
    s_add_u32 m0, s49, 99328
    s_mov_b32 s47, 11136
    buffer_load_dwordx4 v3, s[28:31], s47 offen  lds
    s_add_u32 m0, s49, 115712
    s_mov_b32 s47, 1735680
    buffer_load_dwordx4 v4, s[32:35], s47 offen  lds
    s_add_u32 m0, s49, 100352
    s_mov_b32 s47, 21376
    buffer_load_dwordx4 v2, s[28:31], s47 offen  lds
    s_add_u32 m0, s49, 116736
    s_mov_b32 s47, 1751040
    buffer_load_dwordx4 v5, s[32:35], s47 offen  lds
    s_add_u32 m0, s49, 101376
    s_mov_b32 s47, 31616
    buffer_load_dwordx4 v3, s[28:31], s47 offen  lds
    s_add_u32 m0, s49, 117760
    s_mov_b32 s47, 1766400
    buffer_load_dwordx4 v5, s[32:35], s47 offen  lds
    s_waitcnt vmcnt(16)
    s_barrier
    s_add_u32 m0, s49, 0
    s_mov_b32 s47, 1024
    buffer_load_dwordx4 v2, s[28:31], s47 offen  lds
    s_add_u32 m0, s49, 16384
    s_mov_b32 s47, 1966080
    buffer_load_dwordx4 v4, s[32:35], s47 offen  lds
    s_add_u32 m0, s49, 1024
    s_mov_b32 s47, 11264
    buffer_load_dwordx4 v3, s[28:31], s47 offen  lds
    s_add_u32 m0, s49, 17408
    s_mov_b32 s47, 1981440
    buffer_load_dwordx4 v4, s[32:35], s47 offen  lds
    s_add_u32 m0, s49, 2048
    s_mov_b32 s47, 21504
    buffer_load_dwordx4 v2, s[28:31], s47 offen  lds
    s_add_u32 m0, s49, 18432
    s_mov_b32 s47, 1996800
    buffer_load_dwordx4 v5, s[32:35], s47 offen  lds
    s_add_u32 m0, s49, 3072
    s_mov_b32 s47, 31744
    buffer_load_dwordx4 v3, s[28:31], s47 offen  lds
    s_add_u32 m0, s49, 19456
    s_mov_b32 s47, 2012160
    buffer_load_dwordx4 v5, s[32:35], s47 offen  lds
    v_and_b32 v17, 31, v1
    v_lshl_add_u32 v17, v17, 3, s44
    v_lshlrev_b32 v17, 7, v17
    s_mov_b32 s47, 14778368
    buffer_load_dword v18, v17, s[36:39], s47 offen sc1
    s_waitcnt vmcnt(16)
    s_barrier
    s_add_u32 m0, s49, 32768
    s_mov_b32 s47, 1152
    buffer_load_dwordx4 v2, s[28:31], s47 offen  lds
    s_add_u32 m0, s49, 49152
    s_mov_b32 s47, 2211840
    buffer_load_dwordx4 v4, s[32:35], s47 offen  lds
    s_add_u32 m0, s49, 33792
    s_mov_b32 s47, 11392
    buffer_load_dwordx4 v3, s[28:31], s47 offen  lds
    s_add_u32 m0, s49, 50176
    s_mov_b32 s47, 2227200
    buffer_load_dwordx4 v4, s[32:35], s47 offen  lds
    s_add_u32 m0, s49, 34816
    s_mov_b32 s47, 21632
    buffer_load_dwordx4 v2, s[28:31], s47 offen  lds
    s_add_u32 m0, s49, 51200
    s_mov_b32 s47, 2242560
    buffer_load_dwordx4 v5, s[32:35], s47 offen  lds
    s_add_u32 m0, s49, 35840
    s_mov_b32 s47, 31872
    buffer_load_dwordx4 v3, s[28:31], s47 offen  lds
    s_add_u32 m0, s49, 52224
    s_mov_b32 s47, 2257920
    buffer_load_dwordx4 v5, s[32:35], s47 offen  lds
    s_waitcnt vmcnt(16)
    s_barrier
    s_cmp_lg_u32 s46, 5
    s_cbranch_scc1 L_mf_12
    s_waitcnt vmcnt(8)
    v_subrev_u32 v18, s26, v18
    v_cmp_lt_u32 vcc, 15, v18
    s_cbranch_vccz L_mok_13
    s_mov_b32 s47, 0
    s_mov_b32 s48, 14778368
L_poll_14:
    buffer_load_dword v18, v17, s[36:39], s48 offen sc1
    s_waitcnt vmcnt(0)
    v_subrev_u32 v18, s26, v18
    v_cmp_lt_u32 vcc, 15, v18
    s_cbranch_vccz L_polld_15
    s_add_u32 s47, s47, 1
    s_cmp_lt_u32 s47, 0x100000
    s_cbranch_scc1 L_poll_14
L_polld_15:
L_mok_13:
    v_readfirstlane_b32 s47, v18
    v_mov_b32 v19, 131072
    s_nop 0
    v_cmp_ne_u32 vcc, s47, v18
    s_cmp_eq_u64 vcc, 0
    s_cselect_b32 s47, 1, 0
    s_mov_b64 exec, 1
    v_mov_b32 v17, s47
    ds_write_b32 v19, v17 offset:32280
    s_mov_b64 exec, -1
    s_mov_b64 exec, 1
    v_mov_b32 v18, s26
    ds_write_b32 v19, v18 offset:32284
    s_mov_b64 exec, -1
    s_waitcnt lgkmcnt(0)
L_mf_12:
    s_waitcnt vmcnt(8)
    s_barrier
    s_waitcnt vmcnt(0)
    s_barrier
    s_barrier
    s_mul_i32 s47, s45, 52
    s_lshr_b32 s47, s47, 8
    s_mul_i32 s63, s47, 5
    s_sub_u32 s63, s45, s63
    s_lshl_b32 s62, s47, 3
    s_add_u32 s62, s62, s44
    s_cmp_gt_u32 s62, 32
    s_cbranch_scc1 L_noy_16
    s_waitcnt vmcnt(0)
    s_sub_u32 s64, s46, 4
    s_and_b32 s65, s64, 1
    s_lshr_b32 s66, s64, 1
    s_lshl_b32 s67, s64, 13
    s_add_u32 s67, s67, 0
    v_mov_b32 v8, 131072
    v_and_b32 v20, 0x13, v1
    v_bfe_u32 v21, v1, 2, 1
    v_lshl_add_u32 v20, v21, 3, v20
    v_bfe_u32 v21, v1, 3, 1
    v_lshl_add_u32 v20, v21, 2, v20
    v_lshrrev_b32 v21, 5, v1
    v_mul_u32_u24 v22, 10240, v21
    v_lshl_add_u32 v20, v20, 4, v22
    s_and_b32 s54, s62, 31
    s_mul_i32 s54, s54, 81920
    s_mul_i32 s55, s65, 5120
    s_add_u32 s54, s54, s55
    s_mul_i32 s55, s66, 3072
    s_add_u32 s55, s55, s54
    v_add_u32 v18, s55, v20
    s_mul_i32 s55, s66, 512
    s_add_u32 s55, s55, s54
    s_add_u32 s55, s55, 2048
    v_add_u32 v7, s55, v20
    v_and_b32 v20, 31, v1
    v_lshl_add_u32 v22, v20, 6, s62
    v_cvt_f32_u32 v11, v22
    v_mul_f32 v11, 973078528, v11
    v_lshlrev_b32 v22, 2, v21
    v_cvt_f32_u32 v22, v22
    v_mul_f32 v12, v11, v22
    s_lshl_b32 s54, s63, 6
    s_add_u32 s54, s54, s65
    v_lshl_add_u32 v22, v20, 1, s54
    v_cvt_f32_u32 v13, v22
    v_mul_f32 v13, 986500301, v13
    s_mul_i32 s54, s66, 192
    v_lshl_add_u32 v22, v21, 3, s54
    v_cvt_f32_u32 v22, v22
    v_mul_f32 v14, v13, v22
    s_lshl_b32 s54, s66, 5
    s_add_u32 s54, s54, 128
    v_lshl_add_u32 v22, v21, 3, s54
    v_cvt_f32_u32 v22, v22
    v_mul_f32 v16, v13, v22
    v_and_b32 v23, 15, v1
    v_add_u32 v9, 240, v23
    v_lshlrev_b32 v9, 7, v9
    v_add_f32 v20, v11, v11
    v_cos_f32 v216, v11
    v_sin_f32 v217, v11
    v_cos_f32 v218, v20
    v_sin_f32 v219, v20
    v_fmamk_f32 v20, v11, 0, v12
    v_cos_f32 v224, v20
    v_sin_f32 v225, v20
    s_nop 0
    v_pk_mul_f32 v[240:241], v[224:225], v[216:217] op_sel:[0,0] op_sel_hi:[1,0]
    v_pk_fma_f32 v[226:227], v[224:225], v[216:217], v[240:241] op_sel:[1,1,0] op_sel_hi:[0,1,1] neg_lo:[0,1,0]
    v_pk_mul_f32 v[240:241], v[224:225], v[218:219] op_sel:[0,0] op_sel_hi:[1,0]
    v_pk_mul_f32 v[242:243], v[226:227], v[218:219] op_sel:[0,0] op_sel_hi:[1,0]
    v_pk_fma_f32 v[228:229], v[224:225], v[218:219], v[240:241] op_sel:[1,1,0] op_sel_hi:[0,1,1] neg_lo:[0,1,0]
    v_pk_fma_f32 v[230:231], v[226:227], v[218:219], v[242:243] op_sel:[1,1,0] op_sel_hi:[0,1,1] neg_lo:[0,1,0]
    v_cvt_pk_bf16_f32 v24, v224, v225
    v_cvt_pk_bf16_f32 v40, -v225, v224
    v_cvt_pk_bf16_f32 v25, v226, v227
    v_cvt_pk_bf16_f32 v41, -v227, v226
    v_cvt_pk_bf16_f32 v26, v228, v229
    v_cvt_pk_bf16_f32 v42, -v229, v228
    v_cvt_pk_bf16_f32 v27, v230, v231
    v_cvt_pk_bf16_f32 v43, -v231, v230
    v_fmamk_f32 v20, v11, 1090519040, v12
    v_cos_f32 v224, v20
    v_sin_f32 v225, v20
    s_nop 0
    v_pk_mul_f32 v[240:241], v[224:225], v[216:217] op_sel:[0,0] op_sel_hi:[1,0]
    v_pk_fma_f32 v[226:227], v[224:225], v[216:217], v[240:241] op_sel:[1,1,0] op_sel_hi:[0,1,1] neg_lo:[0,1,0]
    v_pk_mul_f32 v[240:241], v[224:225], v[218:219] op_sel:[0,0] op_sel_hi:[1,0]
    v_pk_mul_f32 v[242:243], v[226:227], v[218:219] op_sel:[0,0] op_sel_hi:[1,0]
    v_pk_fma_f32 v[228:229], v[224:225], v[218:219], v[240:241] op_sel:[1,1,0] op_sel_hi:[0,1,1] neg_lo:[0,1,0]
    v_pk_fma_f32 v[230:231], v[226:227], v[218:219], v[242:243] op_sel:[1,1,0] op_sel_hi:[0,1,1] neg_lo:[0,1,0]
    v_cvt_pk_bf16_f32 v28, v224, v225
    v_cvt_pk_bf16_f32 v44, -v225, v224
    v_cvt_pk_bf16_f32 v29, v226, v227
    v_cvt_pk_bf16_f32 v45, -v227, v226
    v_cvt_pk_bf16_f32 v30, v228, v229
    v_cvt_pk_bf16_f32 v46, -v229, v228
    v_cvt_pk_bf16_f32 v31, v230, v231
    v_cvt_pk_bf16_f32 v47, -v231, v230
    v_fmamk_f32 v20, v11, 1098907648, v12
    v_cos_f32 v224, v20
    v_sin_f32 v225, v20
    s_nop 0
    v_pk_mul_f32 v[240:241], v[224:225], v[216:217] op_sel:[0,0] op_sel_hi:[1,0]
    v_pk_fma_f32 v[226:227], v[224:225], v[216:217], v[240:241] op_sel:[1,1,0] op_sel_hi:[0,1,1] neg_lo:[0,1,0]
    v_pk_mul_f32 v[240:241], v[224:225], v[218:219] op_sel:[0,0] op_sel_hi:[1,0]
    v_pk_mul_f32 v[242:243], v[226:227], v[218:219] op_sel:[0,0] op_sel_hi:[1,0]
    v_pk_fma_f32 v[228:229], v[224:225], v[218:219], v[240:241] op_sel:[1,1,0] op_sel_hi:[0,1,1] neg_lo:[0,1,0]
    v_pk_fma_f32 v[230:231], v[226:227], v[218:219], v[242:243] op_sel:[1,1,0] op_sel_hi:[0,1,1] neg_lo:[0,1,0]
    v_cvt_pk_bf16_f32 v32, v224, v225
    v_cvt_pk_bf16_f32 v48, -v225, v224
    v_cvt_pk_bf16_f32 v33, v226, v227
    v_cvt_pk_bf16_f32 v49, -v227, v226
    v_cvt_pk_bf16_f32 v34, v228, v229
    v_cvt_pk_bf16_f32 v50, -v229, v228
    v_cvt_pk_bf16_f32 v35, v230, v231
    v_cvt_pk_bf16_f32 v51, -v231, v230
    v_fmamk_f32 v20, v11, 1103101952, v12
    v_cos_f32 v224, v20
    v_sin_f32 v225, v20
    s_nop 0
    v_pk_mul_f32 v[240:241], v[224:225], v[216:217] op_sel:[0,0] op_sel_hi:[1,0]
    v_pk_fma_f32 v[226:227], v[224:225], v[216:217], v[240:241] op_sel:[1,1,0] op_sel_hi:[0,1,1] neg_lo:[0,1,0]
    v_pk_mul_f32 v[240:241], v[224:225], v[218:219] op_sel:[0,0] op_sel_hi:[1,0]
    v_pk_mul_f32 v[242:243], v[226:227], v[218:219] op_sel:[0,0] op_sel_hi:[1,0]
    v_pk_fma_f32 v[228:229], v[224:225], v[218:219], v[240:241] op_sel:[1,1,0] op_sel_hi:[0,1,1] neg_lo:[0,1,0]
    v_pk_fma_f32 v[230:231], v[226:227], v[218:219], v[242:243] op_sel:[1,1,0] op_sel_hi:[0,1,1] neg_lo:[0,1,0]
    v_cvt_pk_bf16_f32 v36, v224, v225
    v_cvt_pk_bf16_f32 v52, -v225, v224
    v_cvt_pk_bf16_f32 v37, v226, v227
    v_cvt_pk_bf16_f32 v53, -v227, v226
    v_cvt_pk_bf16_f32 v38, v228, v229
    v_cvt_pk_bf16_f32 v54, -v229, v228
    v_cvt_pk_bf16_f32 v39, v230, v231
    v_cvt_pk_bf16_f32 v55, -v231, v230
    v_add_f32 v20, v13, v13
    v_cos_f32 v216, v13
    v_sin_f32 v217, v13
    v_cos_f32 v218, v20
    v_sin_f32 v219, v20
    v_fmamk_f32 v20, v13, 0, v14
    v_cos_f32 v224, v20
    v_sin_f32 v225, v20
    s_nop 0
    v_pk_mul_f32 v[240:241], v[224:225], v[216:217] op_sel:[0,0] op_sel_hi:[1,0]
    v_pk_fma_f32 v[226:227], v[224:225], v[216:217], v[240:241] op_sel:[1,1,0] op_sel_hi:[0,1,1] neg_lo:[0,1,0]
    v_pk_mul_f32 v[240:241], v[224:225], v[218:219] op_sel:[0,0] op_sel_hi:[1,0]
    v_pk_mul_f32 v[242:243], v[226:227], v[218:219] op_sel:[0,0] op_sel_hi:[1,0]
    v_pk_fma_f32 v[228:229], v[224:225], v[218:219], v[240:241] op_sel:[1,1,0] op_sel_hi:[0,1,1] neg_lo:[0,1,0]
    v_pk_fma_f32 v[230:231], v[226:227], v[218:219], v[242:243] op_sel:[1,1,0] op_sel_hi:[0,1,1] neg_lo:[0,1,0]
    v_pk_mul_f32 v[240:241], v[228:229], v[218:219] op_sel:[0,0] op_sel_hi:[1,0]
    v_pk_mul_f32 v[242:243], v[230:231], v[218:219] op_sel:[0,0] op_sel_hi:[1,0]
    v_pk_fma_f32 v[232:233], v[228:229], v[218:219], v[240:241] op_sel:[1,1,0] op_sel_hi:[0,1,1] neg_lo:[0,1,0]
    v_pk_fma_f32 v[234:235], v[230:231], v[218:219], v[242:243] op_sel:[1,1,0] op_sel_hi:[0,1,1] neg_lo:[0,1,0]
    v_pk_mul_f32 v[240:241], v[232:233], v[218:219] op_sel:[0,0] op_sel_hi:[1,0]
    v_pk_mul_f32 v[242:243], v[234:235], v[218:219] op_sel:[0,0] op_sel_hi:[1,0]
    v_pk_fma_f32 v[236:237], v[232:233], v[218:219], v[240:241] op_sel:[1,1,0] op_sel_hi:[0,1,1] neg_lo:[0,1,0]
    v_pk_fma_f32 v[238:239], v[234:235], v[218:219], v[242:243] op_sel:[1,1,0] op_sel_hi:[0,1,1] neg_lo:[0,1,0]
    v_cvt_pk_bf16_f32 v136, v224, v226
    v_cvt_pk_bf16_f32 v176, -v225, -v227
    v_cvt_pk_bf16_f32 v137, v228, v230
    v_cvt_pk_bf16_f32 v177, -v229, -v231
    v_cvt_pk_bf16_f32 v138, v232, v234
    v_cvt_pk_bf16_f32 v178, -v233, -v235
    v_cvt_pk_bf16_f32 v139, v236, v238
    v_cvt_pk_bf16_f32 v179, -v237, -v239
    v_fmamk_f32 v20, v13, 1098907648, v14
    v_cos_f32 v224, v20
    v_sin_f32 v225, v20
    s_nop 0
    v_pk_mul_f32 v[240:241], v[224:225], v[216:217] op_sel:[0,0] op_sel_hi:[1,0]
    v_pk_fma_f32 v[226:227], v[224:225], v[216:217], v[240:241] op_sel:[1,1,0] op_sel_hi:[0,1,1] neg_lo:[0,1,0]
    v_pk_mul_f32 v[240:241], v[224:225], v[218:219] op_sel:[0,0] op_sel_hi:[1,0]
    v_pk_mul_f32 v[242:243], v[226:227], v[218:219] op_sel:[0,0] op_sel_hi:[1,0]
    v_pk_fma_f32 v[228:229], v[224:225], v[218:219], v[240:241] op_sel:[1,1,0] op_sel_hi:[0,1,1] neg_lo:[0,1,0]
    v_pk_fma_f32 v[230:231], v[226:227], v[218:219], v[242:243] op_sel:[1,1,0] op_sel_hi:[0,1,1] neg_lo:[0,1,0]
    v_pk_mul_f32 v[240:241], v[228:229], v[218:219] op_sel:[0,0] op_sel_hi:[1,0]
    v_pk_mul_f32 v[242:243], v[230:231], v[218:219] op_sel:[0,0] op_sel_hi:[1,0]
    v_pk_fma_f32 v[232:233], v[228:229], v[218:219], v[240:241] op_sel:[1,1,0] op_sel_hi:[0,1,1] neg_lo:[0,1,0]
    v_pk_fma_f32 v[234:235], v[230:231], v[218:219], v[242:243] op_sel:[1,1,0] op_sel_hi:[0,1,1] neg_lo:[0,1,0]
    v_pk_mul_f32 v[240:241], v[232:233], v[218:219] op_sel:[0,0] op_sel_hi:[1,0]
    v_pk_mul_f32 v[242:243], v[234:235], v[218:219] op_sel:[0,0] op_sel_hi:[1,0]
    v_pk_fma_f32 v[236:237], v[232:233], v[218:219], v[240:241] op_sel:[1,1,0] op_sel_hi:[0,1,1] neg_lo:[0,1,0]
    v_pk_fma_f32 v[238:239], v[234:235], v[218:219], v[242:243] op_sel:[1,1,0] op_sel_hi:[0,1,1] neg_lo:[0,1,0]
    v_cvt_pk_bf16_f32 v140, v224, v226
    v_cvt_pk_bf16_f32 v180, -v225, -v227
    v_cvt_pk_bf16_f32 v141, v228, v230
    v_cvt_pk_bf16_f32 v181, -v229, -v231
    v_cvt_pk_bf16_f32 v142, v232, v234
    v_cvt_pk_bf16_f32 v182, -v233, -v235
    v_cvt_pk_bf16_f32 v143, v236, v238
    v_cvt_pk_bf16_f32 v183, -v237, -v239
    v_fmamk_f32 v20, v13, 1107296256, v14
    v_cos_f32 v224, v20
    v_sin_f32 v225, v20
    s_nop 0
    v_pk_mul_f32 v[240:241], v[224:225], v[216:217] op_sel:[0,0] op_sel_hi:[1,0]
    v_pk_fma_f32 v[226:227], v[224:225], v[216:217], v[240:241] op_sel:[1,1,0] op_sel_hi:[0,1,1] neg_lo:[0,1,0]
    v_pk_mul_f32 v[240:241], v[224:225], v[218:219] op_sel:[0,0] op_sel_hi:[1,0]
    v_pk_mul_f32 v[242:243], v[226:227], v[218:219] op_sel:[0,0] op_sel_hi:[1,0]
    v_pk_fma_f32 v[228:229], v[224:225], v[218:219], v[240:241] op_sel:[1,1,0] op_sel_hi:[0,1,1] neg_lo:[0,1,0]
    v_pk_fma_f32 v[230:231], v[226:227], v[218:219], v[242:243] op_sel:[1,1,0] op_sel_hi:[0,1,1] neg_lo:[0,1,0]
    v_pk_mul_f32 v[240:241], v[228:229], v[218:219] op_sel:[0,0] op_sel_hi:[1,0]
    v_pk_mul_f32 v[242:243], v[230:231], v[218:219] op_sel:[0,0] op_sel_hi:[1,0]
    v_pk_fma_f32 v[232:233], v[228:229], v[218:219], v[240:241] op_sel:[1,1,0] op_sel_hi:[0,1,1] neg_lo:[0,1,0]
    v_pk_fma_f32 v[234:235], v[230:231], v[218:219], v[242:243] op_sel:[1,1,0] op_sel_hi:[0,1,1] neg_lo:[0,1,0]
    v_pk_mul_f32 v[240:241], v[232:233], v[218:219] op_sel:[0,0] op_sel_hi:[1,0]
    v_pk_mul_f32 v[242:243], v[234:235], v[218:219] op_sel:[0,0] op_sel_hi:[1,0]
    v_pk_fma_f32 v[236:237], v[232:233], v[218:219], v[240:241] op_sel:[1,1,0] op_sel_hi:[0,1,1] neg_lo:[0,1,0]
    v_pk_fma_f32 v[238:239], v[234:235], v[218:219], v[242:243] op_sel:[1,1,0] op_sel_hi:[0,1,1] neg_lo:[0,1,0]
    v_cvt_pk_bf16_f32 v144, v224, v226
    v_cvt_pk_bf16_f32 v184, -v225, -v227
    v_cvt_pk_bf16_f32 v145, v228, v230
    v_cvt_pk_bf16_f32 v185, -v229, -v231
    v_cvt_pk_bf16_f32 v146, v232, v234
    v_cvt_pk_bf16_f32 v186, -v233, -v235
    v_cvt_pk_bf16_f32 v147, v236, v238
    v_cvt_pk_bf16_f32 v187, -v237, -v239
    v_fmamk_f32 v20, v13, 1111490560, v14
    v_cos_f32 v224, v20
    v_sin_f32 v225, v20
    s_nop 0
    v_pk_mul_f32 v[240:241], v[224:225], v[216:217] op_sel:[0,0] op_sel_hi:[1,0]
    v_pk_fma_f32 v[226:227], v[224:225], v[216:217], v[240:241] op_sel:[1,1,0] op_sel_hi:[0,1,1] neg_lo:[0,1,0]
    v_pk_mul_f32 v[240:241], v[224:225], v[218:219] op_sel:[0,0] op_sel_hi:[1,0]
    v_pk_mul_f32 v[242:243], v[226:227], v[218:219] op_sel:[0,0] op_sel_hi:[1,0]
    v_pk_fma_f32 v[228:229], v[224:225], v[218:219], v[240:241] op_sel:[1,1,0] op_sel_hi:[0,1,1] neg_lo:[0,1,0]
    v_pk_fma_f32 v[230:231], v[226:227], v[218:219], v[242:243] op_sel:[1,1,0] op_sel_hi:[0,1,1] neg_lo:[0,1,0]
    v_pk_mul_f32 v[240:241], v[228:229], v[218:219] op_sel:[0,0] op_sel_hi:[1,0]
    v_pk_mul_f32 v[242:243], v[230:231], v[218:219] op_sel:[0,0] op_sel_hi:[1,0]
    v_pk_fma_f32 v[232:233], v[228:229], v[218:219], v[240:241] op_sel:[1,1,0] op_sel_hi:[0,1,1] neg_lo:[0,1,0]
    v_pk_fma_f32 v[234:235], v[230:231], v[218:219], v[242:243] op_sel:[1,1,0] op_sel_hi:[0,1,1] neg_lo:[0,1,0]
    v_pk_mul_f32 v[240:241], v[232:233], v[218:219] op_sel:[0,0] op_sel_hi:[1,0]
    v_pk_mul_f32 v[242:243], v[234:235], v[218:219] op_sel:[0,0] op_sel_hi:[1,0]
    v_pk_fma_f32 v[236:237], v[232:233], v[218:219], v[240:241] op_sel:[1,1,0] op_sel_hi:[0,1,1] neg_lo:[0,1,0]
    v_pk_fma_f32 v[238:239], v[234:235], v[218:219], v[242:243] op_sel:[1,1,0] op_sel_hi:[0,1,1] neg_lo:[0,1,0]
    v_cvt_pk_bf16_f32 v148, v224, v226
    v_cvt_pk_bf16_f32 v188, -v225, -v227
    v_cvt_pk_bf16_f32 v149, v228, v230
    v_cvt_pk_bf16_f32 v189, -v229, -v231
    v_cvt_pk_bf16_f32 v150, v232, v234
    v_cvt_pk_bf16_f32 v190, -v233, -v235
    v_cvt_pk_bf16_f32 v151, v236, v238
    v_cvt_pk_bf16_f32 v191, -v237, -v239
    v_fmamk_f32 v20, v13, 1115684864, v14
    v_cos_f32 v224, v20
    v_sin_f32 v225, v20
    s_nop 0
    v_pk_mul_f32 v[240:241], v[224:225], v[216:217] op_sel:[0,0] op_sel_hi:[1,0]
    v_pk_fma_f32 v[226:227], v[224:225], v[216:217], v[240:241] op_sel:[1,1,0] op_sel_hi:[0,1,1] neg_lo:[0,1,0]
    v_pk_mul_f32 v[240:241], v[224:225], v[218:219] op_sel:[0,0] op_sel_hi:[1,0]
    v_pk_mul_f32 v[242:243], v[226:227], v[218:219] op_sel:[0,0] op_sel_hi:[1,0]
    v_pk_fma_f32 v[228:229], v[224:225], v[218:219], v[240:241] op_sel:[1,1,0] op_sel_hi:[0,1,1] neg_lo:[0,1,0]
    v_pk_fma_f32 v[230:231], v[226:227], v[218:219], v[242:243] op_sel:[1,1,0] op_sel_hi:[0,1,1] neg_lo:[0,1,0]
    v_pk_mul_f32 v[240:241], v[228:229], v[218:219] op_sel:[0,0] op_sel_hi:[1,0]
    v_pk_mul_f32 v[242:243], v[230:231], v[218:219] op_sel:[0,0] op_sel_hi:[1,0]
    v_pk_fma_f32 v[232:233], v[228:229], v[218:219], v[240:241] op_sel:[1,1,0] op_sel_hi:[0,1,1] neg_lo:[0,1,0]
    v_pk_fma_f32 v[234:235], v[230:231], v[218:219], v[242:243] op_sel:[1,1,0] op_sel_hi:[0,1,1] neg_lo:[0,1,0]
    v_pk_mul_f32 v[240:241], v[232:233], v[218:219] op_sel:[0,0] op_sel_hi:[1,0]
    v_pk_mul_f32 v[242:243], v[234:235], v[218:219] op_sel:[0,0] op_sel_hi:[1,0]
    v_pk_fma_f32 v[236:237], v[232:233], v[218:219], v[240:241] op_sel:[1,1,0] op_sel_hi:[0,1,1] neg_lo:[0,1,0]
    v_pk_fma_f32 v[238:239], v[234:235], v[218:219], v[242:243] op_sel:[1,1,0] op_sel_hi:[0,1,1] neg_lo:[0,1,0]
    v_cvt_pk_bf16_f32 v152, v224, v226
    v_cvt_pk_bf16_f32 v192, -v225, -v227
    v_cvt_pk_bf16_f32 v153, v228, v230
    v_cvt_pk_bf16_f32 v193, -v229, -v231
    v_cvt_pk_bf16_f32 v154, v232, v234
    v_cvt_pk_bf16_f32 v194, -v233, -v235
    v_cvt_pk_bf16_f32 v155, v236, v238
    v_cvt_pk_bf16_f32 v195, -v237, -v239
    v_fmamk_f32 v20, v13, 1117782016, v14
    v_cos_f32 v224, v20
    v_sin_f32 v225, v20
    s_nop 0
    v_pk_mul_f32 v[240:241], v[224:225], v[216:217] op_sel:[0,0] op_sel_hi:[1,0]
    v_pk_fma_f32 v[226:227], v[224:225], v[216:217], v[240:241] op_sel:[1,1,0] op_sel_hi:[0,1,1] neg_lo:[0,1,0]
    v_pk_mul_f32 v[240:241], v[224:225], v[218:219] op_sel:[0,0] op_sel_hi:[1,0]
    v_pk_mul_f32 v[242:243], v[226:227], v[218:219] op_sel:[0,0] op_sel_hi:[1,0]
    v_pk_fma_f32 v[228:229], v[224:225], v[218:219], v[240:241] op_sel:[1,1,0] op_sel_hi:[0,1,1] neg_lo:[0,1,0]
    v_pk_fma_f32 v[230:231], v[226:227], v[218:219], v[242:243] op_sel:[1,1,0] op_sel_hi:[0,1,1] neg_lo:[0,1,0]
    v_pk_mul_f32 v[240:241], v[228:229], v[218:219] op_sel:[0,0] op_sel_hi:[1,0]
    v_pk_mul_f32 v[242:243], v[230:231], v[218:219] op_sel:[0,0] op_sel_hi:[1,0]
    v_pk_fma_f32 v[232:233], v[228:229], v[218:219], v[240:241] op_sel:[1,1,0] op_sel_hi:[0,1,1] neg_lo:[0,1,0]
    v_pk_fma_f32 v[234:235], v[230:231], v[218:219], v[242:243] op_sel:[1,1,0] op_sel_hi:[0,1,1] neg_lo:[0,1,0]
    v_pk_mul_f32 v[240:241], v[232:233], v[218:219] op_sel:[0,0] op_sel_hi:[1,0]
    v_pk_mul_f32 v[242:243], v[234:235], v[218:219] op_sel:[0,0] op_sel_hi:[1,0]
    v_pk_fma_f32 v[236:237], v[232:233], v[218:219], v[240:241] op_sel:[1,1,0] op_sel_hi:[0,1,1] neg_lo:[0,1,0]
    v_pk_fma_f32 v[238:239], v[234:235], v[218:219], v[242:243] op_sel:[1,1,0] op_sel_hi:[0,1,1] neg_lo:[0,1,0]
    v_cvt_pk_bf16_f32 v156, v224, v226
    v_cvt_pk_bf16_f32 v196, -v225, -v227
    v_cvt_pk_bf16_f32 v157, v228, v230
    v_cvt_pk_bf16_f32 v197, -v229, -v231
    v_cvt_pk_bf16_f32 v158, v232, v234
    v_cvt_pk_bf16_f32 v198, -v233, -v235
    v_cvt_pk_bf16_f32 v159, v236, v238
    v_cvt_pk_bf16_f32 v199, -v237, -v239
    v_fmamk_f32 v20, v13, 1119879168, v14
    v_cos_f32 v224, v20
    v_sin_f32 v225, v20
    s_nop 0
    v_pk_mul_f32 v[240:241], v[224:225], v[216:217] op_sel:[0,0] op_sel_hi:[1,0]
    v_pk_fma_f32 v[226:227], v[224:225], v[216:217], v[240:241] op_sel:[1,1,0] op_sel_hi:[0,1,1] neg_lo:[0,1,0]
    v_pk_mul_f32 v[240:241], v[224:225], v[218:219] op_sel:[0,0] op_sel_hi:[1,0]
    v_pk_mul_f32 v[242:243], v[226:227], v[218:219] op_sel:[0,0] op_sel_hi:[1,0]
    v_pk_fma_f32 v[228:229], v[224:225], v[218:219], v[240:241] op_sel:[1,1,0] op_sel_hi:[0,1,1] neg_lo:[0,1,0]
    v_pk_fma_f32 v[230:231], v[226:227], v[218:219], v[242:243] op_sel:[1,1,0] op_sel_hi:[0,1,1] neg_lo:[0,1,0]
    v_pk_mul_f32 v[240:241], v[228:229], v[218:219] op_sel:[0,0] op_sel_hi:[1,0]
    v_pk_mul_f32 v[242:243], v[230:231], v[218:219] op_sel:[0,0] op_sel_hi:[1,0]
    v_pk_fma_f32 v[232:233], v[228:229], v[218:219], v[240:241] op_sel:[1,1,0] op_sel_hi:[0,1,1] neg_lo:[0,1,0]
    v_pk_fma_f32 v[234:235], v[230:231], v[218:219], v[242:243] op_sel:[1,1,0] op_sel_hi:[0,1,1] neg_lo:[0,1,0]
    v_pk_mul_f32 v[240:241], v[232:233], v[218:219] op_sel:[0,0] op_sel_hi:[1,0]
    v_pk_mul_f32 v[242:243], v[234:235], v[218:219] op_sel:[0,0] op_sel_hi:[1,0]
    v_pk_fma_f32 v[236:237], v[232:233], v[218:219], v[240:241] op_sel:[1,1,0] op_sel_hi:[0,1,1] neg_lo:[0,1,0]
    v_pk_fma_f32 v[238:239], v[234:235], v[218:219], v[242:243] op_sel:[1,1,0] op_sel_hi:[0,1,1] neg_lo:[0,1,0]
    v_cvt_pk_bf16_f32 v160, v224, v226
    v_cvt_pk_bf16_f32 v200, -v225, -v227
    v_cvt_pk_bf16_f32 v161, v228, v230
    v_cvt_pk_bf16_f32 v201, -v229, -v231
    v_cvt_pk_bf16_f32 v162, v232, v234
    v_cvt_pk_bf16_f32 v202, -v233, -v235
    v_cvt_pk_bf16_f32 v163, v236, v238
    v_cvt_pk_bf16_f32 v203, -v237, -v239
    v_fmamk_f32 v20, v13, 1121976320, v14
    v_cos_f32 v224, v20
    v_sin_f32 v225, v20
    s_nop 0
    v_pk_mul_f32 v[240:241], v[224:225], v[216:217] op_sel:[0,0] op_sel_hi:[1,0]
    v_pk_fma_f32 v[226:227], v[224:225], v[216:217], v[240:241] op_sel:[1,1,0] op_sel_hi:[0,1,1] neg_lo:[0,1,0]
    v_pk_mul_f32 v[240:241], v[224:225], v[218:219] op_sel:[0,0] op_sel_hi:[1,0]
    v_pk_mul_f32 v[242:243], v[226:227], v[218:219] op_sel:[0,0] op_sel_hi:[1,0]
    v_pk_fma_f32 v[228:229], v[224:225], v[218:219], v[240:241] op_sel:[1,1,0] op_sel_hi:[0,1,1] neg_lo:[0,1,0]
    v_pk_fma_f32 v[230:231], v[226:227], v[218:219], v[242:243] op_sel:[1,1,0] op_sel_hi:[0,1,1] neg_lo:[0,1,0]
    v_pk_mul_f32 v[240:241], v[228:229], v[218:219] op_sel:[0,0] op_sel_hi:[1,0]
    v_pk_mul_f32 v[242:243], v[230:231], v[218:219] op_sel:[0,0] op_sel_hi:[1,0]
    v_pk_fma_f32 v[232:233], v[228:229], v[218:219], v[240:241] op_sel:[1,1,0] op_sel_hi:[0,1,1] neg_lo:[0,1,0]
    v_pk_fma_f32 v[234:235], v[230:231], v[218:219], v[242:243] op_sel:[1,1,0] op_sel_hi:[0,1,1] neg_lo:[0,1,0]
    v_pk_mul_f32 v[240:241], v[232:233], v[218:219] op_sel:[0,0] op_sel_hi:[1,0]
    v_pk_mul_f32 v[242:243], v[234:235], v[218:219] op_sel:[0,0] op_sel_hi:[1,0]
    v_pk_fma_f32 v[236:237], v[232:233], v[218:219], v[240:241] op_sel:[1,1,0] op_sel_hi:[0,1,1] neg_lo:[0,1,0]
    v_pk_fma_f32 v[238:239], v[234:235], v[218:219], v[242:243] op_sel:[1,1,0] op_sel_hi:[0,1,1] neg_lo:[0,1,0]
    v_cvt_pk_bf16_f32 v164, v224, v226
    v_cvt_pk_bf16_f32 v204, -v225, -v227
    v_cvt_pk_bf16_f32 v165, v228, v230
    v_cvt_pk_bf16_f32 v205, -v229, -v231
    v_cvt_pk_bf16_f32 v166, v232, v234
    v_cvt_pk_bf16_f32 v206, -v233, -v235
    v_cvt_pk_bf16_f32 v167, v236, v238
    v_cvt_pk_bf16_f32 v207, -v237, -v239
    v_fmamk_f32 v20, v13, 0, v16
    v_cos_f32 v224, v20
    v_sin_f32 v225, v20
    s_nop 0
    v_pk_mul_f32 v[240:241], v[224:225], v[216:217] op_sel:[0,0] op_sel_hi:[1,0]
    v_pk_fma_f32 v[226:227], v[224:225], v[216:217], v[240:241] op_sel:[1,1,0] op_sel_hi:[0,1,1] neg_lo:[0,1,0]
    v_pk_mul_f32 v[240:241], v[224:225], v[218:219] op_sel:[0,0] op_sel_hi:[1,0]
    v_pk_mul_f32 v[242:243], v[226:227], v[218:219] op_sel:[0,0] op_sel_hi:[1,0]
    v_pk_fma_f32 v[228:229], v[224:225], v[218:219], v[240:241] op_sel:[1,1,0] op_sel_hi:[0,1,1] neg_lo:[0,1,0]
    v_pk_fma_f32 v[230:231], v[226:227], v[218:219], v[242:243] op_sel:[1,1,0] op_sel_hi:[0,1,1] neg_lo:[0,1,0]
    v_pk_mul_f32 v[240:241], v[228:229], v[218:219] op_sel:[0,0] op_sel_hi:[1,0]
    v_pk_mul_f32 v[242:243], v[230:231], v[218:219] op_sel:[0,0] op_sel_hi:[1,0]
    v_pk_fma_f32 v[232:233], v[228:229], v[218:219], v[240:241] op_sel:[1,1,0] op_sel_hi:[0,1,1] neg_lo:[0,1,0]
    v_pk_fma_f32 v[234:235], v[230:231], v[218:219], v[242:243] op_sel:[1,1,0] op_sel_hi:[0,1,1] neg_lo:[0,1,0]
    v_pk_mul_f32 v[240:241], v[232:233], v[218:219] op_sel:[0,0] op_sel_hi:[1,0]
    v_pk_mul_f32 v[242:243], v[234:235], v[218:219] op_sel:[0,0] op_sel_hi:[1,0]
    v_pk_fma_f32 v[236:237], v[232:233], v[218:219], v[240:241] op_sel:[1,1,0] op_sel_hi:[0,1,1] neg_lo:[0,1,0]
    v_pk_fma_f32 v[238:239], v[234:235], v[218:219], v[242:243] op_sel:[1,1,0] op_sel_hi:[0,1,1] neg_lo:[0,1,0]
    v_cvt_pk_bf16_f32 v168, v224, v226
    v_cvt_pk_bf16_f32 v208, -v225, -v227
    v_cvt_pk_bf16_f32 v169, v228, v230
    v_cvt_pk_bf16_f32 v209, -v229, -v231
    v_cvt_pk_bf16_f32 v170, v232, v234
    v_cvt_pk_bf16_f32 v210, -v233, -v235
    v_cvt_pk_bf16_f32 v171, v236, v238
    v_cvt_pk_bf16_f32 v211, -v237, -v239
    v_fmamk_f32 v20, v13, 1098907648, v16
    v_cos_f32 v224, v20
    v_sin_f32 v225, v20
    s_nop 0
    v_pk_mul_f32 v[240:241], v[224:225], v[216:217] op_sel:[0,0] op_sel_hi:[1,0]
    v_pk_fma_f32 v[226:227], v[224:225], v[216:217], v[240:241] op_sel:[1,1,0] op_sel_hi:[0,1,1] neg_lo:[0,1,0]
    v_pk_mul_f32 v[240:241], v[224:225], v[218:219] op_sel:[0,0] op_sel_hi:[1,0]
    v_pk_mul_f32 v[242:243], v[226:227], v[218:219] op_sel:[0,0] op_sel_hi:[1,0]
    v_pk_fma_f32 v[228:229], v[224:225], v[218:219], v[240:241] op_sel:[1,1,0] op_sel_hi:[0,1,1] neg_lo:[0,1,0]
    v_pk_fma_f32 v[230:231], v[226:227], v[218:219], v[242:243] op_sel:[1,1,0] op_sel_hi:[0,1,1] neg_lo:[0,1,0]
    v_pk_mul_f32 v[240:241], v[228:229], v[218:219] op_sel:[0,0] op_sel_hi:[1,0]
    v_pk_mul_f32 v[242:243], v[230:231], v[218:219] op_sel:[0,0] op_sel_hi:[1,0]
    v_pk_fma_f32 v[232:233], v[228:229], v[218:219], v[240:241] op_sel:[1,1,0] op_sel_hi:[0,1,1] neg_lo:[0,1,0]
    v_pk_fma_f32 v[234:235], v[230:231], v[218:219], v[242:243] op_sel:[1,1,0] op_sel_hi:[0,1,1] neg_lo:[0,1,0]
    v_pk_mul_f32 v[240:241], v[232:233], v[218:219] op_sel:[0,0] op_sel_hi:[1,0]
    v_pk_mul_f32 v[242:243], v[234:235], v[218:219] op_sel:[0,0] op_sel_hi:[1,0]
    v_pk_fma_f32 v[236:237], v[232:233], v[218:219], v[240:241] op_sel:[1,1,0] op_sel_hi:[0,1,1] neg_lo:[0,1,0]
    v_pk_fma_f32 v[238:239], v[234:235], v[218:219], v[242:243] op_sel:[1,1,0] op_sel_hi:[0,1,1] neg_lo:[0,1,0]
    v_cvt_pk_bf16_f32 v172, v224, v226
    v_cvt_pk_bf16_f32 v212, -v225, -v227
    v_cvt_pk_bf16_f32 v173, v228, v230
    v_cvt_pk_bf16_f32 v213, -v229, -v231
    v_cvt_pk_bf16_f32 v174, v232, v234
    v_cvt_pk_bf16_f32 v214, -v233, -v235
    v_cvt_pk_bf16_f32 v175, v236, v238
    v_cvt_pk_bf16_f32 v215, -v237, -v239
    s_cmp_lg_u32 s62, 0
    s_cbranch_scc1 L_ef_17
    v_and_b32 v24, 0xffff, v24
    v_and_b32 v25, 0xffff, v25
    v_and_b32 v26, 0xffff, v26
    v_and_b32 v27, 0xffff, v27
    v_and_b32 v28, 0xffff, v28
    v_and_b32 v29, 0xffff, v29
    v_and_b32 v30, 0xffff, v30
    v_and_b32 v31, 0xffff, v31
    v_and_b32 v32, 0xffff, v32
    v_and_b32 v33, 0xffff, v33
    v_and_b32 v34, 0xffff, v34
    v_and_b32 v35, 0xffff, v35
    v_and_b32 v36, 0xffff, v36
    v_and_b32 v37, 0xffff, v37
    v_and_b32 v38, 0xffff, v38
    v_and_b32 v39, 0xffff, v39
    v_and_b32 v40, 0xffff, v40
    v_and_b32 v41, 0xffff, v41
    v_and_b32 v42, 0xffff, v42
    v_and_b32 v43, 0xffff, v43
    v_and_b32 v44, 0xffff, v44
    v_and_b32 v45, 0xffff, v45
    v_and_b32 v46, 0xffff, v46
    v_and_b32 v47, 0xffff, v47
    v_and_b32 v48, 0xffff, v48
    v_and_b32 v49, 0xffff, v49
    v_and_b32 v50, 0xffff, v50
    v_and_b32 v51, 0xffff, v51
    v_and_b32 v52, 0xffff, v52
    v_and_b32 v53, 0xffff, v53
    v_and_b32 v54, 0xffff, v54
    v_and_b32 v55, 0xffff, v55
L_ef_17:
    s_cmp_lg_u32 s62, 32
    s_cbranch_scc1 L_ef_18
    v_lshlrev_b32 v24, 16, v24
    v_lshlrev_b32 v25, 16, v25
    v_lshlrev_b32 v26, 16, v26
    v_lshlrev_b32 v27, 16, v27
    v_lshlrev_b32 v28, 16, v28
    v_lshlrev_b32 v29, 16, v29
    v_lshlrev_b32 v30, 16, v30
    v_lshlrev_b32 v31, 16, v31
    v_lshlrev_b32 v32, 16, v32
    v_lshlrev_b32 v33, 16, v33
    v_lshlrev_b32 v34, 16, v34
    v_lshlrev_b32 v35, 16, v35
    v_lshlrev_b32 v36, 16, v36
    v_lshlrev_b32 v37, 16, v37
    v_lshlrev_b32 v38, 16, v38
    v_lshlrev_b32 v39, 16, v39
    v_lshlrev_b32 v40, 16, v40
    v_lshlrev_b32 v41, 16, v41
    v_lshlrev_b32 v42, 16, v42
    v_lshlrev_b32 v43, 16, v43
    v_lshlrev_b32 v44, 16, v44
    v_lshlrev_b32 v45, 16, v45
    v_lshlrev_b32 v46, 16, v46
    v_lshlrev_b32 v47, 16, v47
    v_lshlrev_b32 v48, 16, v48
    v_lshlrev_b32 v49, 16, v49
    v_lshlrev_b32 v50, 16, v50
    v_lshlrev_b32 v51, 16, v51
    v_lshlrev_b32 v52, 16, v52
    v_lshlrev_b32 v53, 16, v53
    v_lshlrev_b32 v54, 16, v54
    v_lshlrev_b32 v55, 16, v55
L_ef_18:
    s_and_b32 s47, s45, 7
    s_mul_i32 s48, s47, 80
    s_lshr_b32 s53, s48, 6
    s_add_u32 s48, s48, 79
    s_lshr_b32 s48, s48, 6
    s_sub_u32 s48, s48, s53
    v_min_u32 v20, 39, v1
    v_lshrrev_b32 v21, 1, v20
    v_mul_u32_u24 v21, 10, v21
    v_and_b32 v20, 1, v20
    v_mul_u32_u24 v20, s48, v20
    v_add3_u32 v20, v20, v21, s53
    v_lshlrev_b32 v17, 7, v20
    s_mul_i32 s47, s47, 1280
    s_and_b32 s52, s46, 3
    s_mul_i32 s48, s52, 40960
    s_add_u32 s48, s48, s47
    s_mul_i32 s53, s52, 5120
    v_add_u32 v20, 0, v1
    v_mul_u32_u24 v21, 820, v20
    v_lshrrev_b32 v21, 16, v21
    v_mul_u32_u24 v22, 8960, v21
    v_lshl_add_u32 v22, v20, 4, v22
    v_add_u32 v2, s48, v22
    v_add_u32 v20, 64, v1
    v_mul_u32_u24 v21, 820, v20
    v_lshrrev_b32 v21, 16, v21
    v_mul_u32_u24 v22, 8960, v21
    v_lshl_add_u32 v22, v20, 4, v22
    v_add_u32 v3, s48, v22
    v_add_u32 v20, 128, v1
    v_mul_u32_u24 v21, 820, v20
    v_lshrrev_b32 v21, 16, v21
    v_mul_u32_u24 v22, 8960, v21
    v_lshl_add_u32 v22, v20, 4, v22
    v_add_u32 v4, s48, v22
    v_add_u32 v20, 192, v1
    v_mul_u32_u24 v21, 820, v20
    v_lshrrev_b32 v21, 16, v21
    v_mul_u32_u24 v22, 8960, v21
    v_lshl_add_u32 v22, v20, 4, v22
    v_add_u32 v5, s48, v22
    v_add_u32 v20, 256, v1
    v_mul_u32_u24 v21, 820, v20
    v_lshrrev_b32 v21, 16, v21
    v_mul_u32_u24 v22, 8960, v21
    v_lshl_add_u32 v22, v20, 4, v22
    v_add_u32 v6, s48, v22
    s_mov_b32 s48, 0
L_ww_21:
    ds_read_b128 v[20:23], v8 offset:32352
    s_waitcnt lgkmcnt(0)
    v_and_b32 v20, v20, v21
    v_and_b32 v22, v22, v23
    v_and_b32 v20, v20, v22
    v_cmp_ne_u32 vcc, 1, v20
    s_cbranch_vccz L_wwd_22
    s_sleep 1
    s_add_u32 s48, s48, 1
    s_cmp_lt_u32 s48, 0x400000
    s_cbranch_scc1 L_ww_21
L_wwd_22:
    v_add_u32 v9, 32768, v9
    s_mov_b32 s47, 0
    s_mov_b32 s48, 14680064
L_poll_23:
    buffer_load_dword v20, v9, s[36:39], s48 offen sc1
    buffer_load_dword v21, v17, s[36:39], s48 offen sc1
    s_waitcnt vmcnt(0)
    v_xor_b32 v20, s26, v20
    v_xor_b32 v21, s26, v21
    v_or_b32 v20, v20, v21
    v_cmp_ne_u32 vcc, 0, v20
    s_cbranch_vccz L_polld_24
    s_add_u32 s47, s47, 1
    s_cmp_lt_u32 s47, 0x100000
    s_cbranch_scc1 L_poll_23
L_polld_24:
    s_mov_b32 s47, 11534336
    buffer_load_dwordx4 v[56:59], v18, s[36:39], s47 offen offset:0 sc1
    s_mov_b32 s47, 11554816
    buffer_load_dwordx4 v[60:63], v18, s[36:39], s47 offen offset:0 sc1
    s_mov_b32 s47, 11575296
    buffer_load_dwordx4 v[64:67], v18, s[36:39], s47 offen offset:0 sc1
    s_mov_b32 s47, 11595776
    buffer_load_dwordx4 v[68:71], v18, s[36:39], s47 offen offset:0 sc1
    s_mov_b32 s47, 11534336
    buffer_load_dwordx4 v[72:75], v18, s[36:39], s47 offen offset:512 sc1
    s_mov_b32 s47, 11554816
    buffer_load_dwordx4 v[76:79], v18, s[36:39], s47 offen offset:512 sc1
    s_mov_b32 s47, 11575296
    buffer_load_dwordx4 v[80:83], v18, s[36:39], s47 offen offset:512 sc1
    s_mov_b32 s47, 11595776
    buffer_load_dwordx4 v[84:87], v18, s[36:39], s47 offen offset:512 sc1
    s_mov_b32 s47, 11534336
    buffer_load_dwordx4 v[88:91], v18, s[36:39], s47 offen offset:1024 sc1
    s_mov_b32 s47, 11554816
    buffer_load_dwordx4 v[92:95], v18, s[36:39], s47 offen offset:1024 sc1
    s_mov_b32 s47, 11575296
    buffer_load_dwordx4 v[96:99], v18, s[36:39], s47 offen offset:1024 sc1
    s_mov_b32 s47, 11595776
    buffer_load_dwordx4 v[100:103], v18, s[36:39], s47 offen offset:1024 sc1
    s_mov_b32 s47, 11534336
    buffer_load_dwordx4 v[104:107], v18, s[36:39], s47 offen offset:1536 sc1
    s_mov_b32 s47, 11554816
    buffer_load_dwordx4 v[108:111], v18, s[36:39], s47 offen offset:1536 sc1
    s_mov_b32 s47, 11575296
    buffer_load_dwordx4 v[112:115], v18, s[36:39], s47 offen offset:1536 sc1
    s_mov_b32 s47, 11595776
    buffer_load_dwordx4 v[116:119], v18, s[36:39], s47 offen offset:1536 sc1
    s_mov_b32 s47, 11534336
    buffer_load_dwordx4 v[120:123], v7, s[36:39], s47 offen offset:0 sc1
    s_mov_b32 s47, 11554816
    buffer_load_dwordx4 v[124:127], v7, s[36:39], s47 offen offset:0 sc1
    s_mov_b32 s47, 11575296
    buffer_load_dwordx4 v[128:131], v7, s[36:39], s47 offen offset:0 sc1
    s_mov_b32 s47, 11595776
    buffer_load_dwordx4 v[132:135], v7, s[36:39], s47 offen offset:0 sc1
    s_add_u32 m0, s53, 57856
    s_mov_b32 s47, 14942208
    buffer_load_dwordx4 v2, s[36:39], s47 offen sc1 lds
    s_add_u32 m0, s53, 58880
    s_mov_b32 s47, 14942208
    buffer_load_dwordx4 v3, s[36:39], s47 offen sc1 lds
    s_add_u32 m0, s53, 59904
    s_mov_b32 s47, 14942208
    buffer_load_dwordx4 v4, s[36:39], s47 offen sc1 lds
    s_add_u32 m0, s53, 60928
    s_mov_b32 s47, 14942208
    buffer_load_dwordx4 v5, s[36:39], s47 offen sc1 lds
    s_add_u32 m0, s53, 61952
    s_mov_b32 s47, 14942208
    buffer_load_dwordx4 v6, s[36:39], s47 offen sc1 lds
    s_add_u32 m0, s53, 78336
    s_mov_b32 s47, 15106048
    buffer_load_dwordx4 v2, s[36:39], s47 offen sc1 lds
    s_add_u32 m0, s53, 79360
    s_mov_b32 s47, 15106048
    buffer_load_dwordx4 v3, s[36:39], s47 offen sc1 lds
    s_add_u32 m0, s53, 80384
    s_mov_b32 s47, 15106048
    buffer_load_dwordx4 v4, s[36:39], s47 offen sc1 lds
    s_add_u32 m0, s53, 81408
    s_mov_b32 s47, 15106048
    buffer_load_dwordx4 v5, s[36:39], s47 offen sc1 lds
    s_add_u32 m0, s53, 82432
    s_mov_b32 s47, 15106048
    buffer_load_dwordx4 v6, s[36:39], s47 offen sc1 lds
    s_add_u32 m0, s53, 98816
    s_mov_b32 s47, 15269888
    buffer_load_dwordx4 v2, s[36:39], s47 offen sc1 lds
    s_add_u32 m0, s53, 99840
    s_mov_b32 s47, 15269888
    buffer_load_dwordx4 v3, s[36:39], s47 offen sc1 lds
    s_add_u32 m0, s53, 100864
    s_mov_b32 s47, 15269888
    buffer_load_dwordx4 v4, s[36:39], s47 offen sc1 lds
    s_add_u32 m0, s53, 101888
    s_mov_b32 s47, 15269888
    buffer_load_dwordx4 v5, s[36:39], s47 offen sc1 lds
    s_add_u32 m0, s53, 102912
    s_mov_b32 s47, 15269888
    buffer_load_dwordx4 v6, s[36:39], s47 offen sc1 lds
    s_add_u32 m0, s53, 119296
    s_mov_b32 s47, 15433728
    buffer_load_dwordx4 v2, s[36:39], s47 offen sc1 lds
    s_add_u32 m0, s53, 120320
    s_mov_b32 s47, 15433728
    buffer_load_dwordx4 v3, s[36:39], s47 offen sc1 lds
    s_add_u32 m0, s53, 121344
    s_mov_b32 s47, 15433728
    buffer_load_dwordx4 v4, s[36:39], s47 offen sc1 lds
    s_add_u32 m0, s53, 122368
    s_mov_b32 s47, 15433728
    buffer_load_dwordx4 v5, s[36:39], s47 offen sc1 lds
    s_add_u32 m0, s53, 123392
    s_mov_b32 s47, 15433728
    buffer_load_dwordx4 v6, s[36:39], s47 offen sc1 lds
    s_add_u32 m0, s53, 139776
    s_mov_b32 s47, 15597568
    buffer_load_dwordx4 v2, s[36:39], s47 offen sc1 lds
    s_add_u32 m0, s53, 140800
    s_mov_b32 s47, 15597568
    buffer_load_dwordx4 v3, s[36:39], s47 offen sc1 lds
    s_add_u32 m0, s53, 141824
    s_mov_b32 s47, 15597568
    buffer_load_dwordx4 v4, s[36:39], s47 offen sc1 lds
    s_add_u32 m0, s53, 142848
    s_mov_b32 s47, 15597568
    buffer_load_dwordx4 v5, s[36:39], s47 offen sc1 lds
    s_add_u32 m0, s53, 143872
    s_mov_b32 s47, 15597568
    buffer_load_dwordx4 v6, s[36:39], s47 offen sc1 lds
    s_waitcnt vmcnt(10)
    s_lshl_b32 s47, s52, 2
    v_add_u32 v21, s47, v8
    s_mov_b64 exec, 1
    v_mov_b32 v20, 1
    ds_write_b32 v21, v20 offset:32336
    s_mov_b64 exec, -1
    s_cmp_lt_u32 s45, 20
    s_cbranch_scc1 L_ts_25
    s_sub_u32 s47, s45, 20
    s_lshl_b32 s47, s47, 2
    s_add_u32 s47, s47, s52
    s_lshl_b32 s48, s47, 16
    s_lshl_b32 s54, s44, 12
    s_add_u32 s48, s48, s54
    s_lshl_b32 s54, s44, 9
    s_add_u32 s54, s54, 6356992
    v_lshrrev_b32 v20, 5, v1
    v_lshlrev_b32 v20, 15, v20
    v_and_b32 v21, 31, v1
    v_lshl_add_u32 v20, v21, 7, v20
    v_add_u32 v20, s48, v20
    v_and_b32 v21, 3, v1
    v_lshl_add_u32 v21, v21, 7, s54
    s_cmp_ge_u32 s47, 40
    s_cselect_b64 s[54:55], -1, 0
    v_cndmask_b32 v20, v20, v21, s[54:55]
    s_mov_b32 s47, 8388608
    buffer_load_dword v7, v20, s[36:39], s47 offen sc1
L_ts_25:
L_gj_20:
    s_mov_b32 s40, s20
    s_mov_b32 s41, s21
    s_mov_b32 s42, 5242880
    s_mov_b32 s43, 0x20000
    v_and_b32 v20, 31, v1
    v_lshrrev_b32 v21, 5, v1
    v_lshlrev_b32 v22, 1, v21
    v_xor_b32 v20, v20, v22
    v_lshl_add_u32 v20, v20, 4, s67
    v_lshl_add_u32 v16, v21, 9, v20
    v_xor_b32 v17, 64, v16
    v_xor_b32 v18, 128, v16
    v_xor_b32 v19, 192, v16
    v_and_b32 v20, 7, v1
    v_lshrrev_b32 v21, 3, v1
    s_lshl_b32 s47, s65, 4
    v_add_u32 v21, s47, v21
    v_lshlrev_b32 v22, 1, v20
    v_xor_b32 v22, v22, v21
    v_lshlrev_b32 v22, 4, v22
    v_lshl_add_u32 v22, v20, 9, v22
    s_lshl_b32 s47, s66, 12
    s_add_u32 s47, s47, 0
    v_add_u32 v9, s47, v22
    v_xor_b32 v10, 128, v9
    v_lshl_add_u32 v21, v21, 6, s62
    v_sub_u32 v22, 2048, v21
    s_mov_b32 s68, 4293656576
    s_cmp_eq_u32 s66, 0
    s_cselect_b64 s[54:55], -1, 0
    s_cselect_b32 s68, 1310720, s68
    v_cndmask_b32 v23, v22, v21, s[54:55]
    v_cndmask_b32 v21, v21, v22, s[54:55]
    v_mul_u32_u24 v23, 2560, v23
    v_mul_u32_u24 v21, 2560, v21
    s_lshl_b32 s47, s63, 7
    s_add_u32 s48, s47, 1280
    v_lshl_add_u32 v23, v20, 4, v23
    v_add_u32 v11, s48, v23
    v_lshlrev_b32 v20, 4, v20
    v_sub_u32 v21, v21, v20
    s_sub_u32 s48, 2546, s47
    v_add_u32 v12, s48, v21
    v_mfma_f32_32x32x16_bf16 v[216:231], v[56:59], v[24:27], 0
    v_mfma_f32_32x32x16_bf16 v[216:231], v[60:63], v[28:31], v[216:231]
    v_mfma_f32_32x32x16_bf16 v[216:231], v[64:67], v[32:35], v[216:231]
    v_mfma_f32_32x32x16_bf16 v[216:231], v[68:71], v[36:39], v[216:231]
    v_mfma_f32_32x32x16_bf16 v[232:247], v[56:59], v[40:43], 0
    v_mfma_f32_32x32x16_bf16 v[232:247], v[60:63], v[44:47], v[232:247]
    s_nop 8
    v_mfma_f32_32x32x16_bf16 v[232:247], v[64:67], v[48:51], v[232:247]
    v_cvt_pk_bf16_f32 v248, v216, v217
    v_cvt_pk_bf16_f32 v249, v218, v219
    v_cvt_pk_bf16_f32 v250, v220, v221
    v_cvt_pk_bf16_f32 v251, v222, v223
    v_mfma_f32_32x32x16_bf16 v[232:247], v[68:71], v[52:55], v[232:247]
    v_cvt_pk_bf16_f32 v252, v224, v225
    v_cvt_pk_bf16_f32 v253, v226, v227
    v_cvt_pk_bf16_f32 v254, v228, v229
    v_cvt_pk_bf16_f32 v255, v230, v231
    s_waitcnt vmcnt(0)
    s_lshl_b32 s47, s64, 2
    v_add_u32 v21, s47, v8
    s_mov_b64 exec, 1
    v_mov_b32 v20, 1
    ds_write_b32 v21, v20 offset:32368
    s_mov_b64 exec, -1
    v_mfma_f32_32x32x16_bf16 v[216:231], v[72:75], v[24:27], 0
    v_mfma_f32_32x32x16_bf16 v[216:231], v[76:79], v[28:31], v[216:231]
    s_nop 7
    v_mfma_f32_32x32x16_bf16 v[216:231], v[80:83], v[32:35], v[216:231]
    v_cvt_pk_bf16_f32 v56, v232, v233
    v_cvt_pk_bf16_f32 v57, v234, v235
    v_cvt_pk_bf16_f32 v58, v236, v237
    v_cvt_pk_bf16_f32 v59, v238, v239
    v_mfma_f32_32x32x16_bf16 v[216:231], v[84:87], v[36:39], v[216:231]
    v_cvt_pk_bf16_f32 v60, v240, v241
    v_cvt_pk_bf16_f32 v61, v242, v243
    v_cvt_pk_bf16_f32 v62, v244, v245
    v_cvt_pk_bf16_f32 v63, v246, v247
    v_mfma_f32_32x32x16_bf16 v[232:247], v[72:75], v[40:43], 0
    v_mfma_f32_32x32x16_bf16 v[232:247], v[76:79], v[44:47], v[232:247]
    s_nop 8
    v_mfma_f32_32x32x16_bf16 v[232:247], v[80:83], v[48:51], v[232:247]
    v_cvt_pk_bf16_f32 v64, v216, v217
    v_cvt_pk_bf16_f32 v65, v218, v219
    v_cvt_pk_bf16_f32 v66, v220, v221
    v_cvt_pk_bf16_f32 v67, v222, v223
    v_mfma_f32_32x32x16_bf16 v[232:247], v[84:87], v[52:55], v[232:247]
    v_cvt_pk_bf16_f32 v68, v224, v225
    v_cvt_pk_bf16_f32 v69, v226, v227
    v_cvt_pk_bf16_f32 v70, v228, v229
    v_cvt_pk_bf16_f32 v71, v230, v231
    v_mfma_f32_32x32x16_bf16 v[216:231], v[88:91], v[24:27], 0
    v_mfma_f32_32x32x16_bf16 v[216:231], v[92:95], v[28:31], v[216:231]
    s_nop 7
    v_mfma_f32_32x32x16_bf16 v[216:231], v[96:99], v[32:35], v[216:231]
    v_cvt_pk_bf16_f32 v72, v232, v233
    v_cvt_pk_bf16_f32 v73, v234, v235
    v_cvt_pk_bf16_f32 v74, v236, v237
    v_cvt_pk_bf16_f32 v75, v238, v239
    v_mfma_f32_32x32x16_bf16 v[216:231], v[100:103], v[36:39], v[216:231]
    v_cvt_pk_bf16_f32 v76, v240, v241
    v_cvt_pk_bf16_f32 v77, v242, v243
    v_cvt_pk_bf16_f32 v78, v244, v245
    v_cvt_pk_bf16_f32 v79, v246, v247
    v_mfma_f32_32x32x16_bf16 v[232:247], v[88:91], v[40:43], 0
    v_mfma_f32_32x32x16_bf16 v[232:247], v[92:95], v[44:47], v[232:247]
    s_nop 8
    v_mfma_f32_32x32x16_bf16 v[232:247], v[96:99], v[48:51], v[232:247]
    v_cvt_pk_bf16_f32 v80, v216, v217
    v_cvt_pk_bf16_f32 v81, v218, v219
    v_cvt_pk_bf16_f32 v82, v220, v221
    v_cvt_pk_bf16_f32 v83, v222, v223
    v_mfma_f32_32x32x16_bf16 v[232:247], v[100:103], v[52:55], v[232:247]
    v_cvt_pk_bf16_f32 v84, v224, v225
    v_cvt_pk_bf16_f32 v85, v226, v227
    v_cvt_pk_bf16_f32 v86, v228, v229
    v_cvt_pk_bf16_f32 v87, v230, v231
    v_mfma_f32_32x32x16_bf16 v[216:231], v[104:107], v[24:27], 0
    v_mfma_f32_32x32x16_bf16 v[216:231], v[108:111], v[28:31], v[216:231]
    s_nop 7
    v_mfma_f32_32x32x16_bf16 v[216:231], v[112:115], v[32:35], v[216:231]
    v_cvt_pk_bf16_f32 v88, v232, v233
    v_cvt_pk_bf16_f32 v89, v234, v235
    v_cvt_pk_bf16_f32 v90, v236, v237
    v_cvt_pk_bf16_f32 v91, v238, v239
    v_mfma_f32_32x32x16_bf16 v[216:231], v[116:119], v[36:39], v[216:231]
    v_cvt_pk_bf16_f32 v92, v240, v241
    v_cvt_pk_bf16_f32 v93, v242, v243
    v_cvt_pk_bf16_f32 v94, v244, v245
    v_cvt_pk_bf16_f32 v95, v246, v247
    v_mfma_f32_32x32x16_bf16 v[232:247], v[104:107], v[40:43], 0
    v_mfma_f32_32x32x16_bf16 v[232:247], v[108:111], v[44:47], v[232:247]
    s_nop 8
    v_mfma_f32_32x32x16_bf16 v[232:247], v[112:115], v[48:51], v[232:247]
    v_cvt_pk_bf16_f32 v96, v216, v217
    v_cvt_pk_bf16_f32 v97, v218, v219
    v_cvt_pk_bf16_f32 v98, v220, v221
    v_cvt_pk_bf16_f32 v99, v222, v223
    v_mfma_f32_32x32x16_bf16 v[232:247], v[116:119], v[52:55], v[232:247]
    v_cvt_pk_bf16_f32 v100, v224, v225
    v_cvt_pk_bf16_f32 v101, v226, v227
    v_cvt_pk_bf16_f32 v102, v228, v229
    v_cvt_pk_bf16_f32 v103, v230, v231
    v_mfma_f32_32x32x16_bf16 v[216:231], v[120:123], v[24:27], 0
    v_mfma_f32_32x32x16_bf16 v[216:231], v[124:127], v[28:31], v[216:231]
    s_nop 7
    v_mfma_f32_32x32x16_bf16 v[216:231], v[128:131], v[32:35], v[216:231]
    v_cvt_pk_bf16_f32 v104, v232, v233
    v_cvt_pk_bf16_f32 v105, v234, v235
    v_cvt_pk_bf16_f32 v106, v236, v237
    v_cvt_pk_bf16_f32 v107, v238, v239
    v_mfma_f32_32x32x16_bf16 v[216:231], v[132:135], v[36:39], v[216:231]
    v_cvt_pk_bf16_f32 v108, v240, v241
    v_cvt_pk_bf16_f32 v109, v242, v243
    v_cvt_pk_bf16_f32 v110, v244, v245
    v_cvt_pk_bf16_f32 v111, v246, v247
    v_mfma_f32_32x32x16_bf16 v[232:247], v[120:123], v[40:43], 0
    v_mfma_f32_32x32x16_bf16 v[232:247], v[124:127], v[44:47], v[232:247]
    s_nop 8
    v_mfma_f32_32x32x16_bf16 v[232:247], v[128:131], v[48:51], v[232:247]
    v_cvt_pk_bf16_f32 v112, v216, v217
    v_cvt_pk_bf16_f32 v113, v218, v219
    v_cvt_pk_bf16_f32 v114, v220, v221
    v_cvt_pk_bf16_f32 v115, v222, v223
    v_mfma_f32_32x32x16_bf16 v[232:247], v[132:135], v[52:55], v[232:247]
    v_cvt_pk_bf16_f32 v116, v224, v225
    v_cvt_pk_bf16_f32 v117, v226, v227
    v_cvt_pk_bf16_f32 v118, v228, v229
    v_cvt_pk_bf16_f32 v119, v230, v231
    s_nop 1
    v_mfma_f32_32x32x16_bf16 v[24:39], v[136:139], v[248:251], 0
    v_mfma_f32_32x32x16_bf16 v[24:39], v[140:143], v[252:255], v[24:39]
    v_mfma_f32_32x32x16_bf16 v[24:39], v[144:147], v[64:67], v[24:39]
    v_mfma_f32_32x32x16_bf16 v[24:39], v[148:151], v[68:71], v[24:39]
    s_nop 3
    v_cvt_pk_bf16_f32 v120, v232, v233
    v_cvt_pk_bf16_f32 v121, v234, v235
    v_cvt_pk_bf16_f32 v122, v236, v237
    v_cvt_pk_bf16_f32 v123, v238, v239
    v_cvt_pk_bf16_f32 v124, v240, v241
    v_cvt_pk_bf16_f32 v125, v242, v243
    v_cvt_pk_bf16_f32 v126, v244, v245
    v_cvt_pk_bf16_f32 v127, v246, v247
    v_mfma_f32_32x32x16_bf16 v[24:39], v[152:155], v[80:83], v[24:39]
    v_mfma_f32_32x32x16_bf16 v[24:39], v[156:159], v[84:87], v[24:39]
    v_mfma_f32_32x32x16_bf16 v[24:39], v[160:163], v[96:99], v[24:39]
    v_mfma_f32_32x32x16_bf16 v[24:39], v[164:167], v[100:103], v[24:39]
    v_mfma_f32_32x32x16_bf16 v[24:39], v[168:171], v[112:115], v[24:39]
    v_mfma_f32_32x32x16_bf16 v[24:39], v[172:175], v[116:119], v[24:39]
    v_mfma_f32_32x32x16_bf16 v[40:55], v[176:179], v[56:59], 0
    v_mfma_f32_32x32x16_bf16 v[40:55], v[180:183], v[60:63], v[40:55]
    v_mfma_f32_32x32x16_bf16 v[40:55], v[184:187], v[72:75], v[40:55]
    v_mfma_f32_32x32x16_bf16 v[40:55], v[188:191], v[76:79], v[40:55]
    v_mfma_f32_32x32x16_bf16 v[40:55], v[192:195], v[88:91], v[40:55]
    v_mfma_f32_32x32x16_bf16 v[40:55], v[196:199], v[92:95], v[40:55]
    v_mfma_f32_32x32x16_bf16 v[40:55], v[200:203], v[104:107], v[40:55]
    v_mfma_f32_32x32x16_bf16 v[40:55], v[204:207], v[108:111], v[40:55]
    v_mfma_f32_32x32x16_bf16 v[40:55], v[208:211], v[120:123], v[40:55]
    v_mfma_f32_32x32x16_bf16 v[40:55], v[212:215], v[124:127], v[40:55]
    s_lshl_b32 s47, s65, 3
    s_add_u32 s47, s47, s63
    s_cmp_lg_u32 s47, 4
    s_cbranch_scc1 L_noz_26
    v_mov_b32 v20, 0xbf803f80
    v_mov_b32 v21, 0xbf803f80
    v_mov_b32 v22, 0xbf803f80
    v_mov_b32 v23, 0xbf803f80
    s_nop 1
    v_mfma_f32_32x32x16_bf16 v[216:231], v[20:23], v[248:251], 0
    v_mfma_f32_32x32x16_bf16 v[216:231], v[20:23], v[252:255], v[216:231]
    v_mfma_f32_32x32x16_bf16 v[216:231], v[20:23], v[64:67], v[216:231]
    v_mfma_f32_32x32x16_bf16 v[216:231], v[20:23], v[68:71], v[216:231]
    v_mfma_f32_32x32x16_bf16 v[216:231], v[20:23], v[80:83], v[216:231]
    v_mfma_f32_32x32x16_bf16 v[216:231], v[20:23], v[84:87], v[216:231]
    v_mfma_f32_32x32x16_bf16 v[216:231], v[20:23], v[96:99], v[216:231]
    v_mfma_f32_32x32x16_bf16 v[216:231], v[20:23], v[100:103], v[216:231]
    v_mfma_f32_32x32x16_bf16 v[216:231], v[20:23], v[112:115], v[216:231]
    v_mfma_f32_32x32x16_bf16 v[216:231], v[20:23], v[116:119], v[216:231]
    s_lshl_b32 s47, s66, 7
    v_and_b32 v20, 31, v1
    v_lshl_add_u32 v20, v20, 2, s47
    v_add_u32 v20, v20, v8
    s_nop 7
    ds_write_b32 v20, v216 offset:32512
L_noz_26:
    s_nop 7
    s_nop 3
    v_sub_f32 v56, v24, v40
    v_add_f32 v60, v24, v40
    v_sub_f32 v57, v25, v41
    v_add_f32 v61, v25, v41
    v_sub_f32 v58, v26, v42
    v_add_f32 v62, v26, v42
    v_sub_f32 v59, v27, v43
    v_add_f32 v63, v27, v43
    v_sub_f32 v64, v28, v44
    v_add_f32 v68, v28, v44
    v_sub_f32 v65, v29, v45
    v_add_f32 v69, v29, v45
    v_sub_f32 v66, v30, v46
    v_add_f32 v70, v30, v46
    v_sub_f32 v67, v31, v47
    v_add_f32 v71, v31, v47
    v_sub_f32 v72, v32, v48
    v_add_f32 v76, v32, v48
    v_sub_f32 v73, v33, v49
    v_add_f32 v77, v33, v49
    v_sub_f32 v74, v34, v50
    v_add_f32 v78, v34, v50
    v_sub_f32 v75, v35, v51
    v_add_f32 v79, v35, v51
    v_sub_f32 v80, v36, v52
    v_add_f32 v84, v36, v52
    v_sub_f32 v81, v37, v53
    v_add_f32 v85, v37, v53
    v_sub_f32 v82, v38, v54
    v_add_f32 v86, v38, v54
    v_sub_f32 v83, v39, v55
    v_add_f32 v87, v39, v55
    s_setprio 0
    s_mov_b32 s48, 0
L_ww_27:
    ds_read_b128 v[20:23], v8 offset:32320
    s_waitcnt lgkmcnt(0)
    v_and_b32 v20, v20, v21
    v_and_b32 v22, v22, v23
    v_and_b32 v20, v20, v22
    v_cmp_ne_u32 vcc, 1, v20
    s_cbranch_vccz L_wwd_28
    s_sleep 1
    s_add_u32 s48, s48, 1
    s_cmp_lt_u32 s48, 0x400000
    s_cbranch_scc1 L_ww_27
L_wwd_28:
    ds_write_b128 v16, v[56:59] offset:0
    ds_write_b128 v16, v[60:63] offset:4096
    ds_write_b128 v17, v[64:67] offset:1024
    ds_write_b128 v17, v[68:71] offset:5120
    ds_write_b128 v18, v[72:75] offset:2048
    ds_write_b128 v18, v[76:79] offset:6144
    ds_write_b128 v19, v[80:83] offset:3072
    ds_write_b128 v19, v[84:87] offset:7168
    s_waitcnt lgkmcnt(0)
    s_lshl_b32 s47, s64, 2
    v_add_u32 v21, s47, v8
    s_mov_b64 exec, 1
    v_mov_b32 v20, 1
    ds_write_b32 v21, v20 offset:32288
    s_mov_b64 exec, -1
    s_mov_b32 s48, 0
L_ww_29:
    ds_read_b128 v[20:23], v8 offset:32288
    s_waitcnt lgkmcnt(0)
    v_and_b32 v20, v20, v21
    v_and_b32 v22, v22, v23
    v_and_b32 v20, v20, v22
    v_cmp_ne_u32 vcc, 1, v20
    s_cbranch_vccz L_wwd_30
    s_add_u32 s48, s48, 1
    s_cmp_lt_u32 s48, 0x400000
    s_cbranch_scc1 L_ww_29
L_wwd_30:
    ds_read_b128 v[88:91], v9 offset:0
    ds_read_b128 v[92:95], v9 offset:8192
    ds_read_b128 v[96:99], v9 offset:16384
    ds_read_b128 v[100:103], v9 offset:24576
    ds_read_b128 v[104:107], v10 offset:0
    ds_read_b128 v[108:111], v10 offset:8192
    ds_read_b128 v[112:115], v10 offset:16384
    ds_read_b128 v[116:119], v10 offset:24576
    s_and_b32 s47, s62, 31
    s_cmp_eq_u32 s47, 0
    s_cselect_b32 s47, 1, 0
    s_and_b32 s56, s47, s66
    s_sub_u32 s57, s47, s56
    s_lshl_b32 s56, s56, 31
    s_lshl_b32 s57, s57, 31
    s_cmp_eq_u32 s63, 0
    s_cselect_b32 s58, 0x01010101, 0
    s_mov_b32 s59, s58
    v_mov_b32 v192, v11
    v_mov_b32 v193, v12
    v_add_u32 v194, s68, v11
    v_subrev_u32 v195, s68, v12
    v_and_b32 v20, 31, v1
    v_lshl_add_u32 v21, v20, 2, v8
    ds_read_b32 v22, v21 offset:32512
    ds_read_b32 v23, v21 offset:32640
    v_lshl_add_u32 v20, v20, 6, s62
    v_sub_u32 v21, 2048, v20
    v_or_b32 v21, s47, v21
    s_lshl_b32 s47, s47, 11
    v_or_b32 v21, s47, v21
    s_mov_b32 s54, 0
    s_mov_b32 s55, -1
    v_cndmask_b32 v20, v20, v21, s[54:55]
    s_lshl_b32 s47, s64, 3
    s_add_u32 s47, s47, s63
    s_cmp_eq_u32 s47, 4
    s_cselect_b32 s47, 0, 2048
    v_or_b32 v20, s47, v20
    v_mul_u32_u24 v196, 2560, v20
    s_waitcnt lgkmcnt(6)
    v_add_f32 v88, v88, v96
    v_add_f32 v92, v92, v100
    v_add_f32 v89, v89, v97
    v_add_f32 v93, v93, v101
    v_add_f32 v90, v90, v98
    v_add_f32 v94, v94, v102
    v_add_f32 v91, v91, v99
    v_add_f32 v95, v95, v103
    v_cvt_pk_bf16_f32 v176, v88, v92
    v_cvt_pk_bf16_f32 v177, v89, v93
    v_cvt_pk_bf16_f32 v178, v90, v94
    v_cvt_pk_bf16_f32 v179, v91, v95
    v_cvt_pk_bf16_f32 v180, v95, v91
    v_cvt_pk_bf16_f32 v181, v94, v90
    v_cvt_pk_bf16_f32 v182, v93, v89
    v_cvt_pk_bf16_f32 v183, v92, v88
    s_waitcnt lgkmcnt(2)
    v_add_f32 v104, v104, v112
    v_add_f32 v108, v108, v116
    v_add_f32 v105, v105, v113
    v_add_f32 v109, v109, v117
    v_add_f32 v106, v106, v114
    v_add_f32 v110, v110, v118
    v_add_f32 v107, v107, v115
    v_add_f32 v111, v111, v119
    v_cvt_pk_bf16_f32 v184, v104, v108
    v_cvt_pk_bf16_f32 v185, v105, v109
    v_cvt_pk_bf16_f32 v186, v106, v110
    v_cvt_pk_bf16_f32 v187, v107, v111
    v_cvt_pk_bf16_f32 v188, v111, v107
    v_cvt_pk_bf16_f32 v189, v110, v106
    v_cvt_pk_bf16_f32 v190, v109, v105
    v_cvt_pk_bf16_f32 v191, v108, v104
    s_waitcnt lgkmcnt(0)
    v_add_f32 v22, v22, v23
    v_cvt_pk_bf16_f32 v197, v22, v22
    s_mov_b32 s48, 0
L_ww_31:
    ds_read_b128 v[20:23], v8 offset:32384
    s_waitcnt lgkmcnt(0)
    v_and_b32 v20, v20, v21
    v_and_b32 v22, v22, v23
    v_and_b32 v20, v20, v22
    v_cmp_ne_u32 vcc, 1, v20
    s_cbranch_vccz L_wwd_32
    s_sleep 1
    s_add_u32 s48, s48, 1
    s_cmp_lt_u32 s48, 0x400000
    s_cbranch_scc1 L_ww_31
L_wwd_32:
    buffer_store_dwordx4 v[176:179], v192, s[40:43], s56 offen
    s_andn2_b64 exec, exec, s[58:59]
    buffer_store_dwordx4 v[180:183], v193, s[40:43], s57 offen
    s_mov_b64 exec, -1
    buffer_store_dwordx4 v[184:187], v194, s[40:43], s56 offen
    s_andn2_b64 exec, exec, s[58:59]
    buffer_store_dwordx4 v[188:191], v195, s[40:43], s57 offen
    s_mov_b64 exec, -1
    buffer_store_short v197, v196, s[40:43], 0 offen offset:1920
    s_cmp_eq_u32 s58, 0
    s_cbranch_scc1 L_ys_33
    s_mov_b64 exec, s[58:59]
    buffer_store_dwordx3 v[180:182], v193, s[40:43], s57 offen
    buffer_store_short v183, v193, s[40:43], s57 offen offset:12
    buffer_store_dwordx3 v[188:190], v195, s[40:43], s57 offen
    buffer_store_short v191, v195, s[40:43], s57 offen offset:12
    s_mov_b64 exec, -1
L_ys_33:
    s_branch L_fin_7
L_noy_16:
    v_mov_b32 v8, 131072
L_high_6:
    s_cmp_lg_u32 s2, 255
    s_cbranch_scc1 L_nn_34
    s_cmp_lg_u32 s46, 7
    s_cbranch_scc1 L_nn_34
    v_lshlrev_b32 v2, 7, v1
    v_add_u32 v3, 8192, v2
    v_add_u32 v4, 16384, v2
    v_add_u32 v5, 24576, v2
    s_mov_b32 s47, 0
    s_mov_b32 s48, 14778368
L_poll_35:
    buffer_load_dword v8, v2, s[36:39], s48 offen sc1
    buffer_load_dword v9, v3, s[36:39], s48 offen sc1
    buffer_load_dword v10, v4, s[36:39], s48 offen sc1
    buffer_load_dword v11, v5, s[36:39], s48 offen sc1
    s_waitcnt vmcnt(0)
    v_subrev_u32 v8, s26, v8
    v_subrev_u32 v9, s26, v9
    v_subrev_u32 v10, s26, v10
    v_subrev_u32 v11, s26, v11
    v_max_u32 v8, v8, v9
    v_max_u32 v8, v8, v10
    v_max_u32 v8, v8, v11
    v_cmp_lt_u32 vcc, 15, v8
    s_cbranch_vccz L_polld_36
    s_add_u32 s47, s47, 1
    s_cmp_lt_u32 s47, 0x100000
    s_cbranch_scc1 L_poll_35
L_polld_36:
    v_mov_b32 v2, 14811136
    v_mov_b32 v3, s26
    s_mov_b64 exec, 1
    buffer_store_dword v3, v2, s[36:39], 0 offen sc1
    s_mov_b64 exec, -1
L_nn_34:
    v_mov_b32 v8, 131072
    s_and_b32 s47, s45, 7
    s_mul_i32 s48, s47, 80
    s_lshr_b32 s53, s48, 6
    s_add_u32 s48, s48, 79
    s_lshr_b32 s48, s48, 6
    s_sub_u32 s48, s48, s53
    v_min_u32 v20, 39, v1
    v_lshrrev_b32 v21, 1, v20
    v_mul_u32_u24 v21, 10, v21
    v_and_b32 v20, 1, v20
    v_mul_u32_u24 v20, s48, v20
    v_add3_u32 v20, v20, v21, s53
    v_lshlrev_b32 v17, 7, v20
    s_mul_i32 s47, s47, 1280
    s_and_b32 s52, s46, 3
    s_mul_i32 s48, s52, 40960
    s_add_u32 s48, s48, s47
    s_mul_i32 s53, s52, 5120
    v_add_u32 v20, 0, v1
    v_mul_u32_u24 v21, 820, v20
    v_lshrrev_b32 v21, 16, v21
    v_mul_u32_u24 v22, 8960, v21
    v_lshl_add_u32 v22, v20, 4, v22
    v_add_u32 v2, s48, v22
    v_add_u32 v20, 64, v1
    v_mul_u32_u24 v21, 820, v20
    v_lshrrev_b32 v21, 16, v21
    v_mul_u32_u24 v22, 8960, v21
    v_lshl_add_u32 v22, v20, 4, v22
    v_add_u32 v3, s48, v22
    v_add_u32 v20, 128, v1
    v_mul_u32_u24 v21, 820, v20
    v_lshrrev_b32 v21, 16, v21
    v_mul_u32_u24 v22, 8960, v21
    v_lshl_add_u32 v22, v20, 4, v22
    v_add_u32 v4, s48, v22
    v_add_u32 v20, 192, v1
    v_mul_u32_u24 v21, 820, v20
    v_lshrrev_b32 v21, 16, v21
    v_mul_u32_u24 v22, 8960, v21
    v_lshl_add_u32 v22, v20, 4, v22
    v_add_u32 v5, s48, v22
    v_add_u32 v20, 256, v1
    v_mul_u32_u24 v21, 820, v20
    v_lshrrev_b32 v21, 16, v21
    v_mul_u32_u24 v22, 8960, v21
    v_lshl_add_u32 v22, v20, 4, v22
    v_add_u32 v6, s48, v22
    s_mov_b32 s48, 0
L_ww_37:
    ds_read_b128 v[20:23], v8 offset:32352
    s_waitcnt lgkmcnt(0)
    v_and_b32 v20, v20, v21
    v_and_b32 v22, v22, v23
    v_and_b32 v20, v20, v22
    v_cmp_ne_u32 vcc, 1, v20
    s_cbranch_vccz L_wwd_38
    s_sleep 1
    s_add_u32 s48, s48, 1
    s_cmp_lt_u32 s48, 0x400000
    s_cbranch_scc1 L_ww_37
L_wwd_38:
    s_mov_b32 s47, 0
    s_mov_b32 s48, 14680064
L_poll_39:
    buffer_load_dword v20, v17, s[36:39], s48 offen sc1
    s_waitcnt vmcnt(0)
    v_xor_b32 v20, s26, v20
    v_cmp_ne_u32 vcc, 0, v20
    s_cbranch_vccz L_polld_40
    s_add_u32 s47, s47, 1
    s_cmp_lt_u32 s47, 0x100000
    s_cbranch_scc1 L_poll_39
L_polld_40:
    s_add_u32 m0, s53, 57856
    s_mov_b32 s47, 14942208
    buffer_load_dwordx4 v2, s[36:39], s47 offen sc1 lds
    s_add_u32 m0, s53, 58880
    s_mov_b32 s47, 14942208
    buffer_load_dwordx4 v3, s[36:39], s47 offen sc1 lds
    s_add_u32 m0, s53, 59904
    s_mov_b32 s47, 14942208
    buffer_load_dwordx4 v4, s[36:39], s47 offen sc1 lds
    s_add_u32 m0, s53, 60928
    s_mov_b32 s47, 14942208
    buffer_load_dwordx4 v5, s[36:39], s47 offen sc1 lds
    s_add_u32 m0, s53, 61952
    s_mov_b32 s47, 14942208
    buffer_load_dwordx4 v6, s[36:39], s47 offen sc1 lds
    s_add_u32 m0, s53, 78336
    s_mov_b32 s47, 15106048
    buffer_load_dwordx4 v2, s[36:39], s47 offen sc1 lds
    s_add_u32 m0, s53, 79360
    s_mov_b32 s47, 15106048
    buffer_load_dwordx4 v3, s[36:39], s47 offen sc1 lds
    s_add_u32 m0, s53, 80384
    s_mov_b32 s47, 15106048
    buffer_load_dwordx4 v4, s[36:39], s47 offen sc1 lds
    s_add_u32 m0, s53, 81408
    s_mov_b32 s47, 15106048
    buffer_load_dwordx4 v5, s[36:39], s47 offen sc1 lds
    s_add_u32 m0, s53, 82432
    s_mov_b32 s47, 15106048
    buffer_load_dwordx4 v6, s[36:39], s47 offen sc1 lds
    s_add_u32 m0, s53, 98816
    s_mov_b32 s47, 15269888
    buffer_load_dwordx4 v2, s[36:39], s47 offen sc1 lds
    s_add_u32 m0, s53, 99840
    s_mov_b32 s47, 15269888
    buffer_load_dwordx4 v3, s[36:39], s47 offen sc1 lds
    s_add_u32 m0, s53, 100864
    s_mov_b32 s47, 15269888
    buffer_load_dwordx4 v4, s[36:39], s47 offen sc1 lds
    s_add_u32 m0, s53, 101888
    s_mov_b32 s47, 15269888
    buffer_load_dwordx4 v5, s[36:39], s47 offen sc1 lds
    s_add_u32 m0, s53, 102912
    s_mov_b32 s47, 15269888
    buffer_load_dwordx4 v6, s[36:39], s47 offen sc1 lds
    s_add_u32 m0, s53, 119296
    s_mov_b32 s47, 15433728
    buffer_load_dwordx4 v2, s[36:39], s47 offen sc1 lds
    s_add_u32 m0, s53, 120320
    s_mov_b32 s47, 15433728
    buffer_load_dwordx4 v3, s[36:39], s47 offen sc1 lds
    s_add_u32 m0, s53, 121344
    s_mov_b32 s47, 15433728
    buffer_load_dwordx4 v4, s[36:39], s47 offen sc1 lds
    s_add_u32 m0, s53, 122368
    s_mov_b32 s47, 15433728
    buffer_load_dwordx4 v5, s[36:39], s47 offen sc1 lds
    s_add_u32 m0, s53, 123392
    s_mov_b32 s47, 15433728
    buffer_load_dwordx4 v6, s[36:39], s47 offen sc1 lds
    s_waitcnt vmcnt(5)
    s_lshl_b32 s47, s52, 2
    v_add_u32 v21, s47, v8
    s_mov_b64 exec, 1
    v_mov_b32 v20, 1
    ds_write_b32 v21, v20 offset:32336
    s_mov_b64 exec, -1
    s_add_u32 m0, s53, 139776
    s_mov_b32 s47, 15597568
    buffer_load_dwordx4 v2, s[36:39], s47 offen sc1 lds
    s_add_u32 m0, s53, 140800
    s_mov_b32 s47, 15597568
    buffer_load_dwordx4 v3, s[36:39], s47 offen sc1 lds
    s_add_u32 m0, s53, 141824
    s_mov_b32 s47, 15597568
    buffer_load_dwordx4 v4, s[36:39], s47 offen sc1 lds
    s_add_u32 m0, s53, 142848
    s_mov_b32 s47, 15597568
    buffer_load_dwordx4 v5, s[36:39], s47 offen sc1 lds
    s_add_u32 m0, s53, 143872
    s_mov_b32 s47, 15597568
    buffer_load_dwordx4 v6, s[36:39], s47 offen sc1 lds
    s_waitcnt vmcnt(0)
    s_lshl_b32 s47, s52, 2
    v_add_u32 v21, s47, v8
    s_mov_b64 exec, 1
    v_mov_b32 v20, 1
    ds_write_b32 v21, v20 offset:32368
    s_mov_b64 exec, -1
    s_cmp_lt_u32 s45, 20
    s_cbranch_scc1 L_ts_41
    s_sub_u32 s47, s45, 20
    s_lshl_b32 s47, s47, 2
    s_add_u32 s47, s47, s52
    s_lshl_b32 s48, s47, 16
    s_lshl_b32 s54, s44, 12
    s_add_u32 s48, s48, s54
    s_lshl_b32 s54, s44, 9
    s_add_u32 s54, s54, 6356992
    v_lshrrev_b32 v20, 5, v1
    v_lshlrev_b32 v20, 15, v20
    v_and_b32 v21, 31, v1
    v_lshl_add_u32 v20, v21, 7, v20
    v_add_u32 v20, s48, v20
    v_and_b32 v21, 3, v1
    v_lshl_add_u32 v21, v21, 7, s54
    s_cmp_ge_u32 s47, 40
    s_cselect_b64 s[54:55], -1, 0
    v_cndmask_b32 v20, v20, v21, s[54:55]
    s_mov_b32 s47, 8388608
    buffer_load_dword v7, v20, s[36:39], s47 offen sc1
L_ts_41:
    s_cmp_lg_u32 s45, 31
    s_cbranch_scc1 L_wb_42
    s_cmp_lg_u32 s46, 7
    s_cbranch_scc1 L_wb_42
    s_mov_b32 s48, 0
L_ww_43:
    ds_read_b128 v[20:23], v8 offset:32400
    s_waitcnt lgkmcnt(0)
    v_and_b32 v20, v20, v21
    v_and_b32 v22, v22, v23
    v_and_b32 v20, v20, v22
    v_cmp_ne_u32 vcc, 1, v20
    s_cbranch_vccz L_wwd_44
    s_sleep 1
    s_add_u32 s48, s48, 1
    s_cmp_lt_u32 s48, 0x400000
    s_cbranch_scc1 L_ww_43
L_wwd_44:
    buffer_wbl2 sc1
L_wb_42:
    s_branch L_fin_7
L_low_2:
    s_getpc_b64 s[40:41]
L_pc_45:
    s_sub_u32 s40, s40, L_pc_45-concat_heads__sliding_block__spectral_fnet__prompt_kernel
    s_subb_u32 s41, s41, 0
    s_mov_b32 s42, L_end_1-concat_heads__sliding_block__spectral_fnet__prompt_kernel
    s_mov_b32 s43, 0x20000
    v_lshlrev_b32 v2, 7, v0
    buffer_load_dword v14, v2, s[40:43], 0 offen
    s_cmp_ge_u32 s45, 30
    s_cbranch_scc1 L_spare_3
    v_mov_b32 v12, 131072
    v_mov_b32 v8, 0
    v_mov_b32 v9, 0
    v_mov_b32 v10, 0
    v_mov_b32 v11, 0
    ds_write_b128 v12, v[8:11] offset:32256
    ds_write_b128 v12, v[8:11] offset:32272
    ds_write_b128 v12, v[8:11] offset:32288
    ds_write_b128 v12, v[8:11] offset:32304
    ds_write_b128 v12, v[8:11] offset:32320
    ds_write_b128 v12, v[8:11] offset:32336
    ds_write_b128 v12, v[8:11] offset:32352
    ds_write_b128 v12, v[8:11] offset:32368
    ds_write_b128 v12, v[8:11] offset:32384
    ds_write_b128 v12, v[8:11] offset:32400
    s_and_b32 s52, s46, 1
    s_lshr_b32 s53, s46, 1
    v_and_b32 v2, 15, v1
    v_lshrrev_b32 v3, 4, v1
    v_bfe_u32 v4, v1, 1, 3
    v_xor_b32 v4, v4, v3
    s_lshl_b32 s47, s53, 13
    v_lshl_add_u32 v5, v2, 7, s47
    v_lshl_add_u32 v16, v4, 4, v5
    v_xor_b32 v17, 64, v16
    v_bfe_u32 v4, v1, 2, 2
    v_lshl_add_u32 v5, v3, 3, v4
    v_lshlrev_b32 v5, 8, v5
    v_and_b32 v6, 3, v1
    v_lshl_add_u32 v5, v6, 3, v5
    v_add_u32 v5, 16384, v5
    v_and_b32 v6, 1, v3
    v_lshl_add_u32 v4, v6, 2, v4
    s_lshl_b32 s47, s52, 2
    v_xor_b32 v4, s47, v4
    v_xor_b32 v6, 0, v4
    v_lshl_add_u32 v18, v6, 5, v5
    v_xor_b32 v6, 1, v4
    v_lshl_add_u32 v19, v6, 5, v5
    v_xor_b32 v6, 2, v4
    v_lshl_add_u32 v20, v6, 5, v5
    v_xor_b32 v6, 3, v4
    v_lshl_add_u32 v21, v6, 5, v5
    v_add_u32 v22, 65536, v16
    v_add_u32 v23, 65536, v17
    v_add_u32 v24, 65536, v18
    v_add_u32 v25, 65536, v19
    v_add_u32 v26, 65536, v20
    v_add_u32 v27, 65536, v21
    s_lshl_b32 s47, s99, 1
    s_add_u32 s47, s47, s52
    s_lshl_b32 s47, s47, 18
    s_lshl_b32 s48, s98, 1
    s_add_u32 s48, s48, s53
    s_lshl_b32 s48, s48, 10
    s_add_u32 s47, s47, s48
    v_lshl_add_u32 v7, v2, 4, s47
    v_and_b32 v6, 1, v3
    v_lshl_add_u32 v7, v6, 16, v7
    v_lshrrev_b32 v6, 1, v3
    v_lshl_add_u32 v7, v6, 15, v7
    v_mov_b32 v8, 131072
    s_waitcnt lgkmcnt(0)
    s_mov_b32 s36, s24
    s_mov_b32 s37, s25
    s_mov_b32 s38, 16777216
    s_mov_b32 s39, 0x20000
    s_cmp_eq_u32 s46, 0
    s_cbranch_scc1 L_bx_46
    s_cmp_eq_u32 s46, 3
    s_cbranch_scc1 L_bx_47
    s_mov_b32 s56, s10
    s_mov_b32 s57, s11
    s_mov_b32 s58, 2621440
    s_mov_b32 s59, 0x20000
    s_lshl_b32 s47, s2, 1
    s_add_u32 s47, s47, s46
    s_sub_u32 s47, s47, 1
    s_mul_i32 s47, s47, 5504
    v_min_u32 v9, 42, v1
    v_lshlrev_b32 v9, 7, v9
    buffer_load_dword v28, v9, s[56:59], s47 offen
    s_branch L_bx_46
L_bx_47:
L_bx_46:
    s_mov_b32 s56, s8
    s_mov_b32 s57, s9
    s_mov_b32 s58, 819200
    s_mov_b32 s59, 0x20000
    s_mul_i32 s47, s2, 6554
    s_lshr_b32 s47, s47, 16
    s_mul_i32 s48, s47, 10
    s_sub_u32 s48, s2, s48
    s_lshl_b32 s50, s47, 2
    s_add_u32 s50, s50, s46
    s_mul_i32 s50, s50, 10240
    s_lshl_b32 s51, s48, 7
    s_add_u32 s50, s50, s51
    v_lshrrev_b32 v9, 3, v1
    v_mul_u32_u24 v9, 1280, v9
    v_lshrrev_b32 v10, 4, v1
    v_lshlrev_b32 v11, 1, v10
    v_and_b32 v12, 7, v1
    v_xor_b32 v11, v11, v12
    v_lshl_add_u32 v9, v11, 4, v9
    s_lshl_b32 s51, s46, 10
    s_add_u32 m0, s51, 131072
    v_mul_u32_u24 v10, 10240, v10
    buffer_load_dwordx4 v9, s[56:59], s50 offen lds
    s_mul_i32 s47, s47, 40960
    s_lshl_b32 s48, s48, 2
    s_add_u32 s48, s48, s46
    s_lshl_b32 s48, s48, 8
    s_add_u32 s47, s47, s48
    s_add_u32 s47, s47, 14942208
    s_cmp_lt_u32 s2, 200
    s_cselect_b32 s47, s47, 16777216
    v_and_b32 v9, 15, v1
    v_lshl_add_u32 v10, v9, 4, v10
    v_add_u32 v13, s47, v10
    v_lshrrev_b32 v9, 4, v1
    v_bfe_u32 v11, v1, 2, 2
    v_lshl_add_u32 v9, v9, 3, v11
    v_and_b32 v10, 3, v1
    v_lshlrev_b32 v10, 3, v10
    v_lshl_add_u32 v10, v9, 7, v10
    v_lshrrev_b32 v11, 1, v11
    v_xor_b32 v9, s46, v11
    v_lshl_add_u32 v9, v9, 5, v10
    v_add_u32 v9, 131072, v9
    v_xor_b32 v10, 64, v9
    s_waitcnt vmcnt(0)
    s_barrier
    ds_read_b64_tr_b16 v[192:193], v9
    ds_read_b64_tr_b16 v[194:195], v10 offset:512
    s_setprio 1
    ds_read_b128 v[48:51], v16 offset:0
    ds_read_b64_tr_b16 v[32:33], v18 offset:0
    ds_read_b64_tr_b16 v[34:35], v18 offset:1024
    ds_read_b64_tr_b16 v[36:37], v19 offset:0
    ds_read_b64_tr_b16 v[38:39], v19 offset:1024
    ds_read_b128 v[52:55], v16 offset:2048
    ds_read_b64_tr_b16 v[40:41], v20 offset:0
    ds_read_b64_tr_b16 v[42:43], v20 offset:1024
    ds_read_b64_tr_b16 v[44:45], v21 offset:0
    ds_read_b64_tr_b16 v[46:47], v21 offset:1024
    ds_read_b128 v[56:59], v16 offset:4096
    ds_read_b128 v[60:63], v16 offset:6144
    s_waitcnt lgkmcnt(0)
    s_nop 0
    v_mfma_f32_16x16x32_bf16 v[96:99], v[32:35], v[48:51], 0
    ds_read_b128 v[80:83], v17 offset:0
    v_mfma_f32_16x16x32_bf16 v[100:103], v[36:39], v[48:51], 0
    ds_read_b64_tr_b16 v[64:65], v18 offset:8192
    v_mfma_f32_16x16x32_bf16 v[104:107], v[40:43], v[48:51], 0
    ds_read_b64_tr_b16 v[66:67], v18 offset:9216
    v_mfma_f32_16x16x32_bf16 v[108:111], v[44:47], v[48:51], 0
    ds_read_b64_tr_b16 v[68:69], v19 offset:8192
    v_mfma_f32_16x16x32_bf16 v[112:115], v[32:35], v[52:55], 0
    ds_read_b64_tr_b16 v[70:71], v19 offset:9216
    v_mfma_f32_16x16x32_bf16 v[116:119], v[36:39], v[52:55], 0
    ds_read_b128 v[84:87], v17 offset:2048
    v_mfma_f32_16x16x32_bf16 v[120:123], v[40:43], v[52:55], 0
    ds_read_b64_tr_b16 v[72:73], v20 offset:8192
    v_mfma_f32_16x16x32_bf16 v[124:127], v[44:47], v[52:55], 0
    ds_read_b64_tr_b16 v[74:75], v20 offset:9216
    v_mfma_f32_16x16x32_bf16 v[128:131], v[32:35], v[56:59], 0
    ds_read_b64_tr_b16 v[76:77], v21 offset:8192
    v_mfma_f32_16x16x32_bf16 v[132:135], v[36:39], v[56:59], 0
    ds_read_b64_tr_b16 v[78:79], v21 offset:9216
    v_mfma_f32_16x16x32_bf16 v[136:139], v[40:43], v[56:59], 0
    ds_read_b128 v[88:91], v17 offset:4096
    v_mfma_f32_16x16x32_bf16 v[140:143], v[44:47], v[56:59], 0
    ds_read_b128 v[92:95], v17 offset:6144
    v_mfma_f32_16x16x32_bf16 v[144:147], v[32:35], v[60:63], 0
    v_mfma_f32_16x16x32_bf16 v[148:151], v[36:39], v[60:63], 0
    v_mfma_f32_16x16x32_bf16 v[152:155], v[40:43], v[60:63], 0
    v_mfma_f32_16x16x32_bf16 v[156:159], v[44:47], v[60:63], 0
    s_waitcnt lgkmcnt(0)
    s_barrier
    v_mfma_f32_16x16x32_bf16 v[96:99], v[64:67], v[80:83], v[96:99]
    ds_read_b128 v[48:51], v16 offset:32768
    v_mfma_f32_16x16x32_bf16 v[100:103], v[68:71], v[80:83], v[100:103]
    ds_read_b64_tr_b16 v[32:33], v18 offset:32768
    v_mfma_f32_16x16x32_bf16 v[104:107], v[72:75], v[80:83], v[104:107]
    ds_read_b64_tr_b16 v[34:35], v18 offset:33792
    v_mfma_f32_16x16x32_bf16 v[108:111], v[76:79], v[80:83], v[108:111]
    ds_read_b64_tr_b16 v[36:37], v19 offset:32768
    v_mfma_f32_16x16x32_bf16 v[112:115], v[64:67], v[84:87], v[112:115]
    ds_read_b64_tr_b16 v[38:39], v19 offset:33792
    v_mfma_f32_16x16x32_bf16 v[116:119], v[68:71], v[84:87], v[116:119]
    ds_read_b128 v[52:55], v16 offset:34816
    v_mfma_f32_16x16x32_bf16 v[120:123], v[72:75], v[84:87], v[120:123]
    ds_read_b64_tr_b16 v[40:41], v20 offset:32768
    v_mfma_f32_16x16x32_bf16 v[124:127], v[76:79], v[84:87], v[124:127]
    ds_read_b64_tr_b16 v[42:43], v20 offset:33792
    v_mfma_f32_16x16x32_bf16 v[128:131], v[64:67], v[88:91], v[128:131]
    ds_read_b64_tr_b16 v[44:45], v21 offset:32768
    v_mfma_f32_16x16x32_bf16 v[132:135], v[68:71], v[88:91], v[132:135]
    ds_read_b64_tr_b16 v[46:47], v21 offset:33792
    v_mfma_f32_16x16x32_bf16 v[136:139], v[72:75], v[88:91], v[136:139]
    ds_read_b128 v[56:59], v16 offset:36864
    v_mfma_f32_16x16x32_bf16 v[140:143], v[76:79], v[88:91], v[140:143]
    ds_read_b128 v[60:63], v16 offset:38912
    v_mfma_f32_16x16x32_bf16 v[144:147], v[64:67], v[92:95], v[144:147]
    v_mfma_f32_16x16x32_bf16 v[148:151], v[68:71], v[92:95], v[148:151]
    v_mfma_f32_16x16x32_bf16 v[152:155], v[72:75], v[92:95], v[152:155]
    v_mfma_f32_16x16x32_bf16 v[156:159], v[76:79], v[92:95], v[156:159]
    s_waitcnt lgkmcnt(0)
    s_nop 0
    v_mfma_f32_16x16x32_bf16 v[96:99], v[32:35], v[48:51], v[96:99]
    ds_read_b128 v[80:83], v17 offset:32768
    v_mfma_f32_16x16x32_bf16 v[100:103], v[36:39], v[48:51], v[100:103]
    ds_read_b64_tr_b16 v[64:65], v18 offset:40960
    v_mfma_f32_16x16x32_bf16 v[104:107], v[40:43], v[48:51], v[104:107]
    ds_read_b64_tr_b16 v[66:67], v18 offset:41984
    v_mfma_f32_16x16x32_bf16 v[108:111], v[44:47], v[48:51], v[108:111]
    ds_read_b64_tr_b16 v[68:69], v19 offset:40960
    v_mfma_f32_16x16x32_bf16 v[112:115], v[32:35], v[52:55], v[112:115]
    ds_read_b64_tr_b16 v[70:71], v19 offset:41984
    v_mfma_f32_16x16x32_bf16 v[116:119], v[36:39], v[52:55], v[116:119]
    ds_read_b128 v[84:87], v17 offset:34816
    v_mfma_f32_16x16x32_bf16 v[120:123], v[40:43], v[52:55], v[120:123]
    ds_read_b64_tr_b16 v[72:73], v20 offset:40960
    v_mfma_f32_16x16x32_bf16 v[124:127], v[44:47], v[52:55], v[124:127]
    ds_read_b64_tr_b16 v[74:75], v20 offset:41984
    v_mfma_f32_16x16x32_bf16 v[128:131], v[32:35], v[56:59], v[128:131]
    ds_read_b64_tr_b16 v[76:77], v21 offset:40960
    v_mfma_f32_16x16x32_bf16 v[132:135], v[36:39], v[56:59], v[132:135]
    ds_read_b64_tr_b16 v[78:79], v21 offset:41984
    v_mfma_f32_16x16x32_bf16 v[136:139], v[40:43], v[56:59], v[136:139]
    ds_read_b128 v[88:91], v17 offset:36864
    v_mfma_f32_16x16x32_bf16 v[140:143], v[44:47], v[56:59], v[140:143]
    ds_read_b128 v[92:95], v17 offset:38912
    v_mfma_f32_16x16x32_bf16 v[144:147], v[32:35], v[60:63], v[144:147]
    v_mfma_f32_16x16x32_bf16 v[148:151], v[36:39], v[60:63], v[148:151]
    v_mfma_f32_16x16x32_bf16 v[152:155], v[40:43], v[60:63], v[152:155]
    v_mfma_f32_16x16x32_bf16 v[156:159], v[44:47], v[60:63], v[156:159]
    s_waitcnt lgkmcnt(0)
    s_barrier
    v_mfma_f32_16x16x32_bf16 v[96:99], v[64:67], v[80:83], v[96:99]
    ds_read_b128 v[48:51], v22 offset:0
    v_mfma_f32_16x16x32_bf16 v[100:103], v[68:71], v[80:83], v[100:103]
    ds_read_b64_tr_b16 v[32:33], v24 offset:0
    v_mfma_f32_16x16x32_bf16 v[104:107], v[72:75], v[80:83], v[104:107]
    ds_read_b64_tr_b16 v[34:35], v24 offset:1024
    v_mfma_f32_16x16x32_bf16 v[108:111], v[76:79], v[80:83], v[108:111]
    ds_read_b64_tr_b16 v[36:37], v25 offset:0
    v_mfma_f32_16x16x32_bf16 v[112:115], v[64:67], v[84:87], v[112:115]
    ds_read_b64_tr_b16 v[38:39], v25 offset:1024
    v_mfma_f32_16x16x32_bf16 v[116:119], v[68:71], v[84:87], v[116:119]
    ds_read_b128 v[52:55], v22 offset:2048
    v_mfma_f32_16x16x32_bf16 v[120:123], v[72:75], v[84:87], v[120:123]
    ds_read_b64_tr_b16 v[40:41], v26 offset:0
    v_mfma_f32_16x16x32_bf16 v[124:127], v[76:79], v[84:87], v[124:127]
    ds_read_b64_tr_b16 v[42:43], v26 offset:1024
    v_mfma_f32_16x16x32_bf16 v[128:131], v[64:67], v[88:91], v[128:131]
    ds_read_b64_tr_b16 v[44:45], v27 offset:0
    v_mfma_f32_16x16x32_bf16 v[132:135], v[68:71], v[88:91], v[132:135]
    ds_read_b64_tr_b16 v[46:47], v27 offset:1024
    v_mfma_f32_16x16x32_bf16 v[136:139], v[72:75], v[88:91], v[136:139]
    ds_read_b128 v[56:59], v22 offset:4096
    v_mfma_f32_16x16x32_bf16 v[140:143], v[76:79], v[88:91], v[140:143]
    ds_read_b128 v[60:63], v22 offset:6144
    v_mfma_f32_16x16x32_bf16 v[144:147], v[64:67], v[92:95], v[144:147]
    v_mfma_f32_16x16x32_bf16 v[148:151], v[68:71], v[92:95], v[148:151]
    v_mfma_f32_16x16x32_bf16 v[152:155], v[72:75], v[92:95], v[152:155]
    v_mfma_f32_16x16x32_bf16 v[156:159], v[76:79], v[92:95], v[156:159]
    s_waitcnt lgkmcnt(0)
    s_nop 0
    v_mfma_f32_16x16x32_bf16 v[96:99], v[32:35], v[48:51], v[96:99]
    ds_read_b128 v[80:83], v23 offset:0
    v_mfma_f32_16x16x32_bf16 v[100:103], v[36:39], v[48:51], v[100:103]
    ds_read_b64_tr_b16 v[64:65], v24 offset:8192
    v_mfma_f32_16x16x32_bf16 v[104:107], v[40:43], v[48:51], v[104:107]
    ds_read_b64_tr_b16 v[66:67], v24 offset:9216
    v_mfma_f32_16x16x32_bf16 v[108:111], v[44:47], v[48:51], v[108:111]
    ds_read_b64_tr_b16 v[68:69], v25 offset:8192
    v_mfma_f32_16x16x32_bf16 v[112:115], v[32:35], v[52:55], v[112:115]
    ds_read_b64_tr_b16 v[70:71], v25 offset:9216
    v_mfma_f32_16x16x32_bf16 v[116:119], v[36:39], v[52:55], v[116:119]
    ds_read_b128 v[84:87], v23 offset:2048
    v_mfma_f32_16x16x32_bf16 v[120:123], v[40:43], v[52:55], v[120:123]
    ds_read_b64_tr_b16 v[72:73], v26 offset:8192
    v_mfma_f32_16x16x32_bf16 v[124:127], v[44:47], v[52:55], v[124:127]
    ds_read_b64_tr_b16 v[74:75], v26 offset:9216
    v_mfma_f32_16x16x32_bf16 v[128:131], v[32:35], v[56:59], v[128:131]
    ds_read_b64_tr_b16 v[76:77], v27 offset:8192
    v_mfma_f32_16x16x32_bf16 v[132:135], v[36:39], v[56:59], v[132:135]
    ds_read_b64_tr_b16 v[78:79], v27 offset:9216
    v_mfma_f32_16x16x32_bf16 v[136:139], v[40:43], v[56:59], v[136:139]
    ds_read_b128 v[88:91], v23 offset:4096
    v_mfma_f32_16x16x32_bf16 v[140:143], v[44:47], v[56:59], v[140:143]
    ds_read_b128 v[92:95], v23 offset:6144
    v_mfma_f32_16x16x32_bf16 v[144:147], v[32:35], v[60:63], v[144:147]
    v_mfma_f32_16x16x32_bf16 v[148:151], v[36:39], v[60:63], v[148:151]
    v_mfma_f32_16x16x32_bf16 v[152:155], v[40:43], v[60:63], v[152:155]
    v_mfma_f32_16x16x32_bf16 v[156:159], v[44:47], v[60:63], v[156:159]
    s_waitcnt lgkmcnt(0)
    s_barrier
    v_mfma_f32_16x16x32_bf16 v[96:99], v[64:67], v[80:83], v[96:99]
    ds_read_b128 v[48:51], v22 offset:32768
    v_mfma_f32_16x16x32_bf16 v[100:103], v[68:71], v[80:83], v[100:103]
    ds_read_b64_tr_b16 v[32:33], v24 offset:32768
    v_mfma_f32_16x16x32_bf16 v[104:107], v[72:75], v[80:83], v[104:107]
    ds_read_b64_tr_b16 v[34:35], v24 offset:33792
    v_mfma_f32_16x16x32_bf16 v[108:111], v[76:79], v[80:83], v[108:111]
    ds_read_b64_tr_b16 v[36:37], v25 offset:32768
    v_mfma_f32_16x16x32_bf16 v[112:115], v[64:67], v[84:87], v[112:115]
    ds_read_b64_tr_b16 v[38:39], v25 offset:33792
    v_mfma_f32_16x16x32_bf16 v[116:119], v[68:71], v[84:87], v[116:119]
    ds_read_b128 v[52:55], v22 offset:34816
    v_mfma_f32_16x16x32_bf16 v[120:123], v[72:75], v[84:87], v[120:123]
    ds_read_b64_tr_b16 v[40:41], v26 offset:32768
    v_mfma_f32_16x16x32_bf16 v[124:127], v[76:79], v[84:87], v[124:127]
    ds_read_b64_tr_b16 v[42:43], v26 offset:33792
    v_mfma_f32_16x16x32_bf16 v[128:131], v[64:67], v[88:91], v[128:131]
    ds_read_b64_tr_b16 v[44:45], v27 offset:32768
    v_mfma_f32_16x16x32_bf16 v[132:135], v[68:71], v[88:91], v[132:135]
    ds_read_b64_tr_b16 v[46:47], v27 offset:33792
    v_mfma_f32_16x16x32_bf16 v[136:139], v[72:75], v[88:91], v[136:139]
    ds_read_b128 v[56:59], v22 offset:36864
    v_mfma_f32_16x16x32_bf16 v[140:143], v[76:79], v[88:91], v[140:143]
    ds_read_b128 v[60:63], v22 offset:38912
    v_mfma_f32_16x16x32_bf16 v[144:147], v[64:67], v[92:95], v[144:147]
    v_mfma_f32_16x16x32_bf16 v[148:151], v[68:71], v[92:95], v[148:151]
    v_mfma_f32_16x16x32_bf16 v[152:155], v[72:75], v[92:95], v[152:155]
    v_mfma_f32_16x16x32_bf16 v[156:159], v[76:79], v[92:95], v[156:159]
    s_waitcnt lgkmcnt(0)
    s_nop 0
    v_mfma_f32_16x16x32_bf16 v[96:99], v[32:35], v[48:51], v[96:99]
    ds_read_b128 v[80:83], v23 offset:32768
    v_mfma_f32_16x16x32_bf16 v[100:103], v[36:39], v[48:51], v[100:103]
    ds_read_b64_tr_b16 v[64:65], v24 offset:40960
    v_mfma_f32_16x16x32_bf16 v[104:107], v[40:43], v[48:51], v[104:107]
    ds_read_b64_tr_b16 v[66:67], v24 offset:41984
    v_mfma_f32_16x16x32_bf16 v[108:111], v[44:47], v[48:51], v[108:111]
    ds_read_b64_tr_b16 v[68:69], v25 offset:40960
    v_mfma_f32_16x16x32_bf16 v[112:115], v[32:35], v[52:55], v[112:115]
    ds_read_b64_tr_b16 v[70:71], v25 offset:41984
    v_mfma_f32_16x16x32_bf16 v[116:119], v[36:39], v[52:55], v[116:119]
    ds_read_b128 v[84:87], v23 offset:34816
    v_mfma_f32_16x16x32_bf16 v[120:123], v[40:43], v[52:55], v[120:123]
    ds_read_b64_tr_b16 v[72:73], v26 offset:40960
    v_mfma_f32_16x16x32_bf16 v[124:127], v[44:47], v[52:55], v[124:127]
    ds_read_b64_tr_b16 v[74:75], v26 offset:41984
    v_mfma_f32_16x16x32_bf16 v[128:131], v[32:35], v[56:59], v[128:131]
    ds_read_b64_tr_b16 v[76:77], v27 offset:40960
    v_mfma_f32_16x16x32_bf16 v[132:135], v[36:39], v[56:59], v[132:135]
    ds_read_b64_tr_b16 v[78:79], v27 offset:41984
    v_mfma_f32_16x16x32_bf16 v[136:139], v[40:43], v[56:59], v[136:139]
    ds_read_b128 v[88:91], v23 offset:36864
    v_mfma_f32_16x16x32_bf16 v[140:143], v[44:47], v[56:59], v[140:143]
    ds_read_b128 v[92:95], v23 offset:38912
    v_mfma_f32_16x16x32_bf16 v[144:147], v[32:35], v[60:63], v[144:147]
    v_mfma_f32_16x16x32_bf16 v[148:151], v[36:39], v[60:63], v[148:151]
    v_mfma_f32_16x16x32_bf16 v[152:155], v[40:43], v[60:63], v[152:155]
    v_mfma_f32_16x16x32_bf16 v[156:159], v[44:47], v[60:63], v[156:159]
    s_waitcnt lgkmcnt(0)
    s_barrier
    v_mfma_f32_16x16x32_bf16 v[96:99], v[64:67], v[80:83], v[96:99]
    ds_read_b128 v[48:51], v16 offset:0
    v_mfma_f32_16x16x32_bf16 v[100:103], v[68:71], v[80:83], v[100:103]
    ds_read_b64_tr_b16 v[32:33], v18 offset:0
    v_mfma_f32_16x16x32_bf16 v[104:107], v[72:75], v[80:83], v[104:107]
    ds_read_b64_tr_b16 v[34:35], v18 offset:1024
    v_mfma_f32_16x16x32_bf16 v[108:111], v[76:79], v[80:83], v[108:111]
    ds_read_b64_tr_b16 v[36:37], v19 offset:0
    v_mfma_f32_16x16x32_bf16 v[112:115], v[64:67], v[84:87], v[112:115]
    ds_read_b64_tr_b16 v[38:39], v19 offset:1024
    v_mfma_f32_16x16x32_bf16 v[116:119], v[68:71], v[84:87], v[116:119]
    ds_read_b128 v[52:55], v16 offset:2048
    v_mfma_f32_16x16x32_bf16 v[120:123], v[72:75], v[84:87], v[120:123]
    ds_read_b64_tr_b16 v[40:41], v20 offset:0
    v_mfma_f32_16x16x32_bf16 v[124:127], v[76:79], v[84:87], v[124:127]
    ds_read_b64_tr_b16 v[42:43], v20 offset:1024
    v_mfma_f32_16x16x32_bf16 v[128:131], v[64:67], v[88:91], v[128:131]
    ds_read_b64_tr_b16 v[44:45], v21 offset:0
    v_mfma_f32_16x16x32_bf16 v[132:135], v[68:71], v[88:91], v[132:135]
    ds_read_b64_tr_b16 v[46:47], v21 offset:1024
    v_mfma_f32_16x16x32_bf16 v[136:139], v[72:75], v[88:91], v[136:139]
    ds_read_b128 v[56:59], v16 offset:4096
    v_mfma_f32_16x16x32_bf16 v[140:143], v[76:79], v[88:91], v[140:143]
    ds_read_b128 v[60:63], v16 offset:6144
    v_mfma_f32_16x16x32_bf16 v[144:147], v[64:67], v[92:95], v[144:147]
    v_mfma_f32_16x16x32_bf16 v[148:151], v[68:71], v[92:95], v[148:151]
    v_mfma_f32_16x16x32_bf16 v[152:155], v[72:75], v[92:95], v[152:155]
    v_mfma_f32_16x16x32_bf16 v[156:159], v[76:79], v[92:95], v[156:159]
    s_waitcnt lgkmcnt(0)
    s_nop 0
    v_mfma_f32_16x16x32_bf16 v[96:99], v[32:35], v[48:51], v[96:99]
    ds_read_b128 v[80:83], v17 offset:0
    v_mfma_f32_16x16x32_bf16 v[100:103], v[36:39], v[48:51], v[100:103]
    ds_read_b64_tr_b16 v[64:65], v18 offset:8192
    v_mfma_f32_16x16x32_bf16 v[104:107], v[40:43], v[48:51], v[104:107]
    ds_read_b64_tr_b16 v[66:67], v18 offset:9216
    v_mfma_f32_16x16x32_bf16 v[108:111], v[44:47], v[48:51], v[108:111]
    ds_read_b64_tr_b16 v[68:69], v19 offset:8192
    v_mfma_f32_16x16x32_bf16 v[112:115], v[32:35], v[52:55], v[112:115]
    ds_read_b64_tr_b16 v[70:71], v19 offset:9216
    v_mfma_f32_16x16x32_bf16 v[116:119], v[36:39], v[52:55], v[116:119]
    ds_read_b128 v[84:87], v17 offset:2048
    v_mfma_f32_16x16x32_bf16 v[120:123], v[40:43], v[52:55], v[120:123]
    ds_read_b64_tr_b16 v[72:73], v20 offset:8192
    v_mfma_f32_16x16x32_bf16 v[124:127], v[44:47], v[52:55], v[124:127]
    ds_read_b64_tr_b16 v[74:75], v20 offset:9216
    v_mfma_f32_16x16x32_bf16 v[128:131], v[32:35], v[56:59], v[128:131]
    ds_read_b64_tr_b16 v[76:77], v21 offset:8192
    v_mfma_f32_16x16x32_bf16 v[132:135], v[36:39], v[56:59], v[132:135]
    ds_read_b64_tr_b16 v[78:79], v21 offset:9216
    v_mfma_f32_16x16x32_bf16 v[136:139], v[40:43], v[56:59], v[136:139]
    ds_read_b128 v[88:91], v17 offset:4096
    v_mfma_f32_16x16x32_bf16 v[140:143], v[44:47], v[56:59], v[140:143]
    ds_read_b128 v[92:95], v17 offset:6144
    v_mfma_f32_16x16x32_bf16 v[144:147], v[32:35], v[60:63], v[144:147]
    v_mfma_f32_16x16x32_bf16 v[148:151], v[36:39], v[60:63], v[148:151]
    v_mfma_f32_16x16x32_bf16 v[152:155], v[40:43], v[60:63], v[152:155]
    v_mfma_f32_16x16x32_bf16 v[156:159], v[44:47], v[60:63], v[156:159]
    s_waitcnt lgkmcnt(0)
    s_barrier
    v_mfma_f32_16x16x32_bf16 v[96:99], v[64:67], v[80:83], v[96:99]
    ds_read_b128 v[48:51], v16 offset:32768
    v_mfma_f32_16x16x32_bf16 v[100:103], v[68:71], v[80:83], v[100:103]
    ds_read_b64_tr_b16 v[32:33], v18 offset:32768
    v_mfma_f32_16x16x32_bf16 v[104:107], v[72:75], v[80:83], v[104:107]
    ds_read_b64_tr_b16 v[34:35], v18 offset:33792
    v_mfma_f32_16x16x32_bf16 v[108:111], v[76:79], v[80:83], v[108:111]
    ds_read_b64_tr_b16 v[36:37], v19 offset:32768
    v_mfma_f32_16x16x32_bf16 v[112:115], v[64:67], v[84:87], v[112:115]
    ds_read_b64_tr_b16 v[38:39], v19 offset:33792
    v_mfma_f32_16x16x32_bf16 v[116:119], v[68:71], v[84:87], v[116:119]
    ds_read_b128 v[52:55], v16 offset:34816
    v_mfma_f32_16x16x32_bf16 v[120:123], v[72:75], v[84:87], v[120:123]
    ds_read_b64_tr_b16 v[40:41], v20 offset:32768
    v_mfma_f32_16x16x32_bf16 v[124:127], v[76:79], v[84:87], v[124:127]
    ds_read_b64_tr_b16 v[42:43], v20 offset:33792
    v_mfma_f32_16x16x32_bf16 v[128:131], v[64:67], v[88:91], v[128:131]
    ds_read_b64_tr_b16 v[44:45], v21 offset:32768
    v_mfma_f32_16x16x32_bf16 v[132:135], v[68:71], v[88:91], v[132:135]
    ds_read_b64_tr_b16 v[46:47], v21 offset:33792
    v_mfma_f32_16x16x32_bf16 v[136:139], v[72:75], v[88:91], v[136:139]
    ds_read_b128 v[56:59], v16 offset:36864
    v_mfma_f32_16x16x32_bf16 v[140:143], v[76:79], v[88:91], v[140:143]
    ds_read_b128 v[60:63], v16 offset:38912
    v_mfma_f32_16x16x32_bf16 v[144:147], v[64:67], v[92:95], v[144:147]
    v_mfma_f32_16x16x32_bf16 v[148:151], v[68:71], v[92:95], v[148:151]
    v_mfma_f32_16x16x32_bf16 v[152:155], v[72:75], v[92:95], v[152:155]
    v_mfma_f32_16x16x32_bf16 v[156:159], v[76:79], v[92:95], v[156:159]
    s_waitcnt lgkmcnt(0)
    s_nop 0
    v_mfma_f32_16x16x32_bf16 v[96:99], v[32:35], v[48:51], v[96:99]
    ds_read_b128 v[80:83], v17 offset:32768
    v_mfma_f32_16x16x32_bf16 v[100:103], v[36:39], v[48:51], v[100:103]
    ds_read_b64_tr_b16 v[64:65], v18 offset:40960
    v_mfma_f32_16x16x32_bf16 v[104:107], v[40:43], v[48:51], v[104:107]
    ds_read_b64_tr_b16 v[66:67], v18 offset:41984
    v_mfma_f32_16x16x32_bf16 v[108:111], v[44:47], v[48:51], v[108:111]
    ds_read_b64_tr_b16 v[68:69], v19 offset:40960
    v_mfma_f32_16x16x32_bf16 v[112:115], v[32:35], v[52:55], v[112:115]
    ds_read_b64_tr_b16 v[70:71], v19 offset:41984
    v_mfma_f32_16x16x32_bf16 v[116:119], v[36:39], v[52:55], v[116:119]
    ds_read_b128 v[84:87], v17 offset:34816
    v_mfma_f32_16x16x32_bf16 v[120:123], v[40:43], v[52:55], v[120:123]
    ds_read_b64_tr_b16 v[72:73], v20 offset:40960
    v_mfma_f32_16x16x32_bf16 v[124:127], v[44:47], v[52:55], v[124:127]
    ds_read_b64_tr_b16 v[74:75], v20 offset:41984
    v_mfma_f32_16x16x32_bf16 v[128:131], v[32:35], v[56:59], v[128:131]
    ds_read_b64_tr_b16 v[76:77], v21 offset:40960
    v_mfma_f32_16x16x32_bf16 v[132:135], v[36:39], v[56:59], v[132:135]
    ds_read_b64_tr_b16 v[78:79], v21 offset:41984
    v_mfma_f32_16x16x32_bf16 v[136:139], v[40:43], v[56:59], v[136:139]
    ds_read_b128 v[88:91], v17 offset:36864
    v_mfma_f32_16x16x32_bf16 v[140:143], v[44:47], v[56:59], v[140:143]
    ds_read_b128 v[92:95], v17 offset:38912
    v_mfma_f32_16x16x32_bf16 v[144:147], v[32:35], v[60:63], v[144:147]
    v_mfma_f32_16x16x32_bf16 v[148:151], v[36:39], v[60:63], v[148:151]
    v_mfma_f32_16x16x32_bf16 v[152:155], v[40:43], v[60:63], v[152:155]
    v_mfma_f32_16x16x32_bf16 v[156:159], v[44:47], v[60:63], v[156:159]
    s_waitcnt lgkmcnt(0)
    s_barrier
    v_mfma_f32_16x16x32_bf16 v[96:99], v[64:67], v[80:83], v[96:99]
    ds_read_b128 v[48:51], v22 offset:0
    v_mfma_f32_16x16x32_bf16 v[100:103], v[68:71], v[80:83], v[100:103]
    ds_read_b64_tr_b16 v[32:33], v24 offset:0
    v_mfma_f32_16x16x32_bf16 v[104:107], v[72:75], v[80:83], v[104:107]
    ds_read_b64_tr_b16 v[34:35], v24 offset:1024
    v_mfma_f32_16x16x32_bf16 v[108:111], v[76:79], v[80:83], v[108:111]
    ds_read_b64_tr_b16 v[36:37], v25 offset:0
    v_mfma_f32_16x16x32_bf16 v[112:115], v[64:67], v[84:87], v[112:115]
    ds_read_b64_tr_b16 v[38:39], v25 offset:1024
    v_mfma_f32_16x16x32_bf16 v[116:119], v[68:71], v[84:87], v[116:119]
    ds_read_b128 v[52:55], v22 offset:2048
    v_mfma_f32_16x16x32_bf16 v[120:123], v[72:75], v[84:87], v[120:123]
    ds_read_b64_tr_b16 v[40:41], v26 offset:0
    v_mfma_f32_16x16x32_bf16 v[124:127], v[76:79], v[84:87], v[124:127]
    ds_read_b64_tr_b16 v[42:43], v26 offset:1024
    v_mfma_f32_16x16x32_bf16 v[128:131], v[64:67], v[88:91], v[128:131]
    ds_read_b64_tr_b16 v[44:45], v27 offset:0
    v_mfma_f32_16x16x32_bf16 v[132:135], v[68:71], v[88:91], v[132:135]
    ds_read_b64_tr_b16 v[46:47], v27 offset:1024
    v_mfma_f32_16x16x32_bf16 v[136:139], v[72:75], v[88:91], v[136:139]
    ds_read_b128 v[56:59], v22 offset:4096
    v_mfma_f32_16x16x32_bf16 v[140:143], v[76:79], v[88:91], v[140:143]
    ds_read_b128 v[60:63], v22 offset:6144
    v_mfma_f32_16x16x32_bf16 v[144:147], v[64:67], v[92:95], v[144:147]
    v_mfma_f32_16x16x32_bf16 v[148:151], v[68:71], v[92:95], v[148:151]
    v_mfma_f32_16x16x32_bf16 v[152:155], v[72:75], v[92:95], v[152:155]
    v_mfma_f32_16x16x32_bf16 v[156:159], v[76:79], v[92:95], v[156:159]
    s_waitcnt lgkmcnt(0)
    s_nop 0
    s_waitcnt vmcnt(0)
    s_nop 0
    v_mfma_f32_16x16x32_bf16 v[96:99], v[32:35], v[48:51], v[96:99]
    ds_read_b128 v[80:83], v23 offset:0
    v_mfma_f32_16x16x32_bf16 v[100:103], v[36:39], v[48:51], v[100:103]
    ds_read_b64_tr_b16 v[64:65], v24 offset:8192
    v_mfma_f32_16x16x32_bf16 v[104:107], v[40:43], v[48:51], v[104:107]
    ds_read_b64_tr_b16 v[66:67], v24 offset:9216
    v_mfma_f32_16x16x32_bf16 v[108:111], v[44:47], v[48:51], v[108:111]
    ds_read_b64_tr_b16 v[68:69], v25 offset:8192
    v_mfma_f32_16x16x32_bf16 v[112:115], v[32:35], v[52:55], v[112:115]
    ds_read_b64_tr_b16 v[70:71], v25 offset:9216
    v_mfma_f32_16x16x32_bf16 v[116:119], v[36:39], v[52:55], v[116:119]
    ds_read_b128 v[84:87], v23 offset:2048
    v_mfma_f32_16x16x32_bf16 v[120:123], v[40:43], v[52:55], v[120:123]
    ds_read_b64_tr_b16 v[72:73], v26 offset:8192
    v_mfma_f32_16x16x32_bf16 v[124:127], v[44:47], v[52:55], v[124:127]
    ds_read_b64_tr_b16 v[74:75], v26 offset:9216
    v_mfma_f32_16x16x32_bf16 v[128:131], v[32:35], v[56:59], v[128:131]
    ds_read_b64_tr_b16 v[76:77], v27 offset:8192
    v_mfma_f32_16x16x32_bf16 v[132:135], v[36:39], v[56:59], v[132:135]
    ds_read_b64_tr_b16 v[78:79], v27 offset:9216
    v_mfma_f32_16x16x32_bf16 v[136:139], v[40:43], v[56:59], v[136:139]
    ds_read_b128 v[88:91], v23 offset:4096
    v_mfma_f32_16x16x32_bf16 v[140:143], v[44:47], v[56:59], v[140:143]
    ds_read_b128 v[92:95], v23 offset:6144
    v_mfma_f32_16x16x32_bf16 v[144:147], v[32:35], v[60:63], v[144:147]
    v_mfma_f32_16x16x32_bf16 v[148:151], v[36:39], v[60:63], v[148:151]
    v_mfma_f32_16x16x32_bf16 v[152:155], v[40:43], v[60:63], v[152:155]
    v_mfma_f32_16x16x32_bf16 v[156:159], v[44:47], v[60:63], v[156:159]
    s_waitcnt lgkmcnt(0)
    s_barrier
    v_mfma_f32_16x16x32_bf16 v[96:99], v[64:67], v[80:83], v[96:99]
    ds_read_b128 v[48:51], v22 offset:32768
    v_mfma_f32_16x16x32_bf16 v[100:103], v[68:71], v[80:83], v[100:103]
    ds_read_b64_tr_b16 v[32:33], v24 offset:32768
    v_mfma_f32_16x16x32_bf16 v[104:107], v[72:75], v[80:83], v[104:107]
    ds_read_b64_tr_b16 v[34:35], v24 offset:33792
    v_mfma_f32_16x16x32_bf16 v[108:111], v[76:79], v[80:83], v[108:111]
    ds_read_b64_tr_b16 v[36:37], v25 offset:32768
    v_mfma_f32_16x16x32_bf16 v[112:115], v[64:67], v[84:87], v[112:115]
    ds_read_b64_tr_b16 v[38:39], v25 offset:33792
    v_mfma_f32_16x16x32_bf16 v[116:119], v[68:71], v[84:87], v[116:119]
    ds_read_b128 v[52:55], v22 offset:34816
    v_mfma_f32_16x16x32_bf16 v[120:123], v[72:75], v[84:87], v[120:123]
    ds_read_b64_tr_b16 v[40:41], v26 offset:32768
    v_mfma_f32_16x16x32_bf16 v[124:127], v[76:79], v[84:87], v[124:127]
    ds_read_b64_tr_b16 v[42:43], v26 offset:33792
    v_mfma_f32_16x16x32_bf16 v[128:131], v[64:67], v[88:91], v[128:131]
    ds_read_b64_tr_b16 v[44:45], v27 offset:32768
    v_mfma_f32_16x16x32_bf16 v[132:135], v[68:71], v[88:91], v[132:135]
    ds_read_b64_tr_b16 v[46:47], v27 offset:33792
    v_mfma_f32_16x16x32_bf16 v[136:139], v[72:75], v[88:91], v[136:139]
    ds_read_b128 v[56:59], v22 offset:36864
    v_mfma_f32_16x16x32_bf16 v[140:143], v[76:79], v[88:91], v[140:143]
    ds_read_b128 v[60:63], v22 offset:38912
    v_mfma_f32_16x16x32_bf16 v[144:147], v[64:67], v[92:95], v[144:147]
    v_mfma_f32_16x16x32_bf16 v[148:151], v[68:71], v[92:95], v[148:151]
    v_mfma_f32_16x16x32_bf16 v[152:155], v[72:75], v[92:95], v[152:155]
    v_mfma_f32_16x16x32_bf16 v[156:159], v[76:79], v[92:95], v[156:159]
    s_waitcnt lgkmcnt(0)
    s_nop 0
    v_mfma_f32_16x16x32_bf16 v[96:99], v[32:35], v[48:51], v[96:99]
    ds_read_b128 v[80:83], v23 offset:32768
    v_mfma_f32_16x16x32_bf16 v[100:103], v[36:39], v[48:51], v[100:103]
    ds_read_b64_tr_b16 v[64:65], v24 offset:40960
    v_mfma_f32_16x16x32_bf16 v[104:107], v[40:43], v[48:51], v[104:107]
    ds_read_b64_tr_b16 v[66:67], v24 offset:41984
    v_mfma_f32_16x16x32_bf16 v[108:111], v[44:47], v[48:51], v[108:111]
    ds_read_b64_tr_b16 v[68:69], v25 offset:40960
    v_mfma_f32_16x16x32_bf16 v[112:115], v[32:35], v[52:55], v[112:115]
    ds_read_b64_tr_b16 v[70:71], v25 offset:41984
    v_mfma_f32_16x16x32_bf16 v[116:119], v[36:39], v[52:55], v[116:119]
    ds_read_b128 v[84:87], v23 offset:34816
    v_mfma_f32_16x16x32_bf16 v[120:123], v[40:43], v[52:55], v[120:123]
    ds_read_b64_tr_b16 v[72:73], v26 offset:40960
    v_mfma_f32_16x16x32_bf16 v[124:127], v[44:47], v[52:55], v[124:127]
    ds_read_b64_tr_b16 v[74:75], v26 offset:41984
    v_mfma_f32_16x16x32_bf16 v[128:131], v[32:35], v[56:59], v[128:131]
    ds_read_b64_tr_b16 v[76:77], v27 offset:40960
    v_mfma_f32_16x16x32_bf16 v[132:135], v[36:39], v[56:59], v[132:135]
    ds_read_b64_tr_b16 v[78:79], v27 offset:41984
    v_mfma_f32_16x16x32_bf16 v[136:139], v[40:43], v[56:59], v[136:139]
    ds_read_b128 v[88:91], v23 offset:36864
    v_mfma_f32_16x16x32_bf16 v[140:143], v[44:47], v[56:59], v[140:143]
    ds_read_b128 v[92:95], v23 offset:38912
    v_mfma_f32_16x16x32_bf16 v[144:147], v[32:35], v[60:63], v[144:147]
    v_mfma_f32_16x16x32_bf16 v[148:151], v[36:39], v[60:63], v[148:151]
    v_mfma_f32_16x16x32_bf16 v[152:155], v[40:43], v[60:63], v[152:155]
    v_mfma_f32_16x16x32_bf16 v[156:159], v[44:47], v[60:63], v[156:159]
    s_waitcnt lgkmcnt(0)
    s_barrier
    v_mfma_f32_16x16x32_bf16 v[96:99], v[64:67], v[80:83], v[96:99]
    ds_read_b128 v[48:51], v16 offset:0
    v_mfma_f32_16x16x32_bf16 v[100:103], v[68:71], v[80:83], v[100:103]
    ds_read_b64_tr_b16 v[32:33], v18 offset:0
    v_mfma_f32_16x16x32_bf16 v[104:107], v[72:75], v[80:83], v[104:107]
    ds_read_b64_tr_b16 v[34:35], v18 offset:1024
    v_mfma_f32_16x16x32_bf16 v[108:111], v[76:79], v[80:83], v[108:111]
    ds_read_b64_tr_b16 v[36:37], v19 offset:0
    v_mfma_f32_16x16x32_bf16 v[112:115], v[64:67], v[84:87], v[112:115]
    ds_read_b64_tr_b16 v[38:39], v19 offset:1024
    v_mfma_f32_16x16x32_bf16 v[116:119], v[68:71], v[84:87], v[116:119]
    ds_read_b128 v[52:55], v16 offset:2048
    v_mfma_f32_16x16x32_bf16 v[120:123], v[72:75], v[84:87], v[120:123]
    ds_read_b64_tr_b16 v[40:41], v20 offset:0
    v_mfma_f32_16x16x32_bf16 v[124:127], v[76:79], v[84:87], v[124:127]
    ds_read_b64_tr_b16 v[42:43], v20 offset:1024
    v_mfma_f32_16x16x32_bf16 v[128:131], v[64:67], v[88:91], v[128:131]
    ds_read_b64_tr_b16 v[44:45], v21 offset:0
    v_mfma_f32_16x16x32_bf16 v[132:135], v[68:71], v[88:91], v[132:135]
    ds_read_b64_tr_b16 v[46:47], v21 offset:1024
    v_mfma_f32_16x16x32_bf16 v[136:139], v[72:75], v[88:91], v[136:139]
    ds_read_b128 v[56:59], v16 offset:4096
    v_mfma_f32_16x16x32_bf16 v[140:143], v[76:79], v[88:91], v[140:143]
    ds_read_b128 v[60:63], v16 offset:6144
    v_mfma_f32_16x16x32_bf16 v[144:147], v[64:67], v[92:95], v[144:147]
    v_mfma_f32_16x16x32_bf16 v[148:151], v[68:71], v[92:95], v[148:151]
    v_mfma_f32_16x16x32_bf16 v[152:155], v[72:75], v[92:95], v[152:155]
    v_mfma_f32_16x16x32_bf16 v[156:159], v[76:79], v[92:95], v[156:159]
    s_waitcnt lgkmcnt(0)
    s_nop 0
    ds_read_b64 v[10:11], v8 offset:32280
    v_mfma_f32_16x16x32_bf16 v[96:99], v[32:35], v[48:51], v[96:99]
    ds_read_b128 v[80:83], v17 offset:0
    v_mfma_f32_16x16x32_bf16 v[100:103], v[36:39], v[48:51], v[100:103]
    ds_read_b64_tr_b16 v[64:65], v18 offset:8192
    v_mfma_f32_16x16x32_bf16 v[104:107], v[40:43], v[48:51], v[104:107]
    ds_read_b64_tr_b16 v[66:67], v18 offset:9216
    v_mfma_f32_16x16x32_bf16 v[108:111], v[44:47], v[48:51], v[108:111]
    ds_read_b64_tr_b16 v[68:69], v19 offset:8192
    v_mfma_f32_16x16x32_bf16 v[112:115], v[32:35], v[52:55], v[112:115]
    ds_read_b64_tr_b16 v[70:71], v19 offset:9216
    v_mfma_f32_16x16x32_bf16 v[116:119], v[36:39], v[52:55], v[116:119]
    ds_read_b128 v[84:87], v17 offset:2048
    v_mfma_f32_16x16x32_bf16 v[120:123], v[40:43], v[52:55], v[120:123]
    ds_read_b64_tr_b16 v[72:73], v20 offset:8192
    v_mfma_f32_16x16x32_bf16 v[124:127], v[44:47], v[52:55], v[124:127]
    ds_read_b64_tr_b16 v[74:75], v20 offset:9216
    v_mfma_f32_16x16x32_bf16 v[128:131], v[32:35], v[56:59], v[128:131]
    ds_read_b64_tr_b16 v[76:77], v21 offset:8192
    v_mfma_f32_16x16x32_bf16 v[132:135], v[36:39], v[56:59], v[132:135]
    ds_read_b64_tr_b16 v[78:79], v21 offset:9216
    v_mfma_f32_16x16x32_bf16 v[136:139], v[40:43], v[56:59], v[136:139]
    ds_read_b128 v[88:91], v17 offset:4096
    v_mfma_f32_16x16x32_bf16 v[140:143], v[44:47], v[56:59], v[140:143]
    ds_read_b128 v[92:95], v17 offset:6144
    v_mfma_f32_16x16x32_bf16 v[144:147], v[32:35], v[60:63], v[144:147]
    v_mfma_f32_16x16x32_bf16 v[148:151], v[36:39], v[60:63], v[148:151]
    v_mfma_f32_16x16x32_bf16 v[152:155], v[40:43], v[60:63], v[152:155]
    v_mfma_f32_16x16x32_bf16 v[156:159], v[44:47], v[60:63], v[156:159]
    s_waitcnt lgkmcnt(0)
    s_barrier
    buffer_store_dwordx4 v[192:195], v13, s[36:39], 0 offen sc1
    v_readfirstlane_b32 s27, v10
    v_readfirstlane_b32 s26, v11
    v_mfma_f32_16x16x32_bf16 v[96:99], v[64:67], v[80:83], v[96:99]
    ds_read_b128 v[48:51], v16 offset:32768
    v_mfma_f32_16x16x32_bf16 v[100:103], v[68:71], v[80:83], v[100:103]
    ds_read_b64_tr_b16 v[32:33], v18 offset:32768
    v_mfma_f32_16x16x32_bf16 v[104:107], v[72:75], v[80:83], v[104:107]
    ds_read_b64_tr_b16 v[34:35], v18 offset:33792
    v_mfma_f32_16x16x32_bf16 v[108:111], v[76:79], v[80:83], v[108:111]
    ds_read_b64_tr_b16 v[36:37], v19 offset:32768
    v_mfma_f32_16x16x32_bf16 v[112:115], v[64:67], v[84:87], v[112:115]
    ds_read_b64_tr_b16 v[38:39], v19 offset:33792
    v_mfma_f32_16x16x32_bf16 v[116:119], v[68:71], v[84:87], v[116:119]
    ds_read_b128 v[52:55], v16 offset:34816
    v_mfma_f32_16x16x32_bf16 v[120:123], v[72:75], v[84:87], v[120:123]
    ds_read_b64_tr_b16 v[40:41], v20 offset:32768
    v_mfma_f32_16x16x32_bf16 v[124:127], v[76:79], v[84:87], v[124:127]
    ds_read_b64_tr_b16 v[42:43], v20 offset:33792
    v_mfma_f32_16x16x32_bf16 v[128:131], v[64:67], v[88:91], v[128:131]
    ds_read_b64_tr_b16 v[44:45], v21 offset:32768
    v_mfma_f32_16x16x32_bf16 v[132:135], v[68:71], v[88:91], v[132:135]
    ds_read_b64_tr_b16 v[46:47], v21 offset:33792
    v_mfma_f32_16x16x32_bf16 v[136:139], v[72:75], v[88:91], v[136:139]
    ds_read_b128 v[56:59], v16 offset:36864
    v_mfma_f32_16x16x32_bf16 v[140:143], v[76:79], v[88:91], v[140:143]
    ds_read_b128 v[60:63], v16 offset:38912
    v_mfma_f32_16x16x32_bf16 v[144:147], v[64:67], v[92:95], v[144:147]
    v_mfma_f32_16x16x32_bf16 v[148:151], v[68:71], v[92:95], v[148:151]
    v_mfma_f32_16x16x32_bf16 v[152:155], v[72:75], v[92:95], v[152:155]
    v_mfma_f32_16x16x32_bf16 v[156:159], v[76:79], v[92:95], v[156:159]
    s_waitcnt lgkmcnt(0)
    s_cmp_lt_u32 s99, 5
    s_cselect_b32 s47, 1051011932, 1.0
    v_mov_b32 v3, s47
    v_mfma_f32_16x16x32_bf16 v[96:99], v[32:35], v[48:51], v[96:99]
    ds_read_b128 v[80:83], v17 offset:32768
    ds_read_b64_tr_b16 v[64:65], v18 offset:40960
    v_mfma_f32_16x16x32_bf16 v[100:103], v[36:39], v[48:51], v[100:103]
    ds_read_b64_tr_b16 v[66:67], v18 offset:41984
    ds_read_b64_tr_b16 v[68:69], v19 offset:40960
    v_mfma_f32_16x16x32_bf16 v[104:107], v[40:43], v[48:51], v[104:107]
    ds_read_b64_tr_b16 v[70:71], v19 offset:41984
    ds_read_b128 v[84:87], v17 offset:34816
    v_mfma_f32_16x16x32_bf16 v[108:111], v[44:47], v[48:51], v[108:111]
    ds_read_b64_tr_b16 v[72:73], v20 offset:40960
    ds_read_b64_tr_b16 v[74:75], v20 offset:41984
    v_mfma_f32_16x16x32_bf16 v[112:115], v[32:35], v[52:55], v[112:115]
    ds_read_b64_tr_b16 v[76:77], v21 offset:40960
    ds_read_b64_tr_b16 v[78:79], v21 offset:41984
    v_mfma_f32_16x16x32_bf16 v[116:119], v[36:39], v[52:55], v[116:119]
    ds_read_b128 v[88:91], v17 offset:36864
    ds_read_b128 v[92:95], v17 offset:38912
    v_mfma_f32_16x16x32_bf16 v[120:123], v[40:43], v[52:55], v[120:123]
    v_mfma_f32_16x16x32_bf16 v[124:127], v[44:47], v[52:55], v[124:127]
    s_waitcnt lgkmcnt(0)
    s_barrier
    s_mov_b32 s53, 0
    s_cmp_lt_u32 s99, 5
    s_cbranch_scc1 L_qp_48
    v_mfma_f32_16x16x32_bf16 v[96:99], v[64:67], v[80:83], v[96:99]
    v_mfma_f32_16x16x32_bf16 v[100:103], v[68:71], v[80:83], v[100:103]
    v_mfma_f32_16x16x32_bf16 v[104:107], v[72:75], v[80:83], v[104:107]
    v_mfma_f32_16x16x32_bf16 v[108:111], v[76:79], v[80:83], v[108:111]
    v_mfma_f32_16x16x32_bf16 v[112:115], v[64:67], v[84:87], v[112:115]
    v_mfma_f32_16x16x32_bf16 v[116:119], v[68:71], v[84:87], v[116:119]
    s_nop 3
    v_mfma_f32_16x16x32_bf16 v[120:123], v[72:75], v[84:87], v[120:123]
    v_cvt_pk_bf16_f32 v160, v96, v97
    v_cvt_pk_bf16_f32 v161, v98, v99
    v_cvt_pk_bf16_f32 v162, v100, v101
    v_mfma_f32_16x16x32_bf16 v[124:127], v[76:79], v[84:87], v[124:127]
    v_cvt_pk_bf16_f32 v163, v102, v103
    s_mov_b32 s47, 0
    s_nop 0
    v_permlane16_swap_b32 v160, v162
    v_mfma_f32_16x16x32_bf16 v[128:131], v[32:35], v[56:59], v[128:131]
    v_permlane16_swap_b32 v161, v163
    buffer_store_dwordx4 v[160:163], v7, s[36:39], s47 offen offset:0 sc1
    v_cvt_pk_bf16_f32 v164, v104, v105
    v_mfma_f32_16x16x32_bf16 v[132:135], v[36:39], v[56:59], v[132:135]
    v_cvt_pk_bf16_f32 v165, v106, v107
    v_cvt_pk_bf16_f32 v166, v108, v109
    v_cvt_pk_bf16_f32 v167, v110, v111
    v_mfma_f32_16x16x32_bf16 v[136:139], v[40:43], v[56:59], v[136:139]
    s_mov_b32 s47, 131072
    s_nop 0
    v_permlane16_swap_b32 v164, v166
    v_permlane16_swap_b32 v165, v167
    v_mfma_f32_16x16x32_bf16 v[140:143], v[44:47], v[56:59], v[140:143]
    buffer_store_dwordx4 v[164:167], v7, s[36:39], s47 offen offset:0 sc1
    v_mfma_f32_16x16x32_bf16 v[128:131], v[64:67], v[88:91], v[128:131]
    v_mfma_f32_16x16x32_bf16 v[132:135], v[68:71], v[88:91], v[132:135]
    s_nop 3
    v_mfma_f32_16x16x32_bf16 v[136:139], v[72:75], v[88:91], v[136:139]
    v_cvt_pk_bf16_f32 v168, v112, v113
    v_cvt_pk_bf16_f32 v169, v114, v115
    v_cvt_pk_bf16_f32 v170, v116, v117
    v_mfma_f32_16x16x32_bf16 v[140:143], v[76:79], v[88:91], v[140:143]
    v_cvt_pk_bf16_f32 v171, v118, v119
    s_mov_b32 s47, 0
    s_nop 0
    v_permlane16_swap_b32 v168, v170
    v_mfma_f32_16x16x32_bf16 v[144:147], v[32:35], v[60:63], v[144:147]
    v_permlane16_swap_b32 v169, v171
    buffer_store_dwordx4 v[168:171], v7, s[36:39], s47 offen offset:256 sc1
    v_cvt_pk_bf16_f32 v172, v120, v121
    v_mfma_f32_16x16x32_bf16 v[148:151], v[36:39], v[60:63], v[148:151]
    v_cvt_pk_bf16_f32 v173, v122, v123
    v_cvt_pk_bf16_f32 v174, v124, v125
    v_cvt_pk_bf16_f32 v175, v126, v127
    v_mfma_f32_16x16x32_bf16 v[152:155], v[40:43], v[60:63], v[152:155]
    s_mov_b32 s47, 131072
    s_nop 0
    v_permlane16_swap_b32 v172, v174
    v_permlane16_swap_b32 v173, v175
    v_mfma_f32_16x16x32_bf16 v[156:159], v[44:47], v[60:63], v[156:159]
    buffer_store_dwordx4 v[172:175], v7, s[36:39], s47 offen offset:256 sc1
    v_mfma_f32_16x16x32_bf16 v[144:147], v[64:67], v[92:95], v[144:147]
    v_mfma_f32_16x16x32_bf16 v[148:151], v[68:71], v[92:95], v[148:151]
    s_nop 3
    v_mfma_f32_16x16x32_bf16 v[152:155], v[72:75], v[92:95], v[152:155]
    v_cvt_pk_bf16_f32 v176, v128, v129
    v_cvt_pk_bf16_f32 v177, v130, v131
    v_cvt_pk_bf16_f32 v178, v132, v133
    v_cvt_pk_bf16_f32 v179, v134, v135
    s_mov_b32 s47, 0
    s_nop 0
    v_permlane16_swap_b32 v176, v178
    v_permlane16_swap_b32 v177, v179
    buffer_store_dwordx4 v[176:179], v7, s[36:39], s47 offen offset:512 sc1
    v_mfma_f32_16x16x32_bf16 v[156:159], v[76:79], v[92:95], v[156:159]
    v_cvt_pk_bf16_f32 v180, v136, v137
    v_cvt_pk_bf16_f32 v181, v138, v139
    v_cvt_pk_bf16_f32 v182, v140, v141
    v_cvt_pk_bf16_f32 v183, v142, v143
    s_mov_b32 s47, 131072
    s_nop 0
    v_permlane16_swap_b32 v180, v182
    v_permlane16_swap_b32 v181, v183
    buffer_store_dwordx4 v[180:183], v7, s[36:39], s47 offen offset:512 sc1
    s_nop 3
    v_cvt_pk_bf16_f32 v184, v144, v145
    v_cvt_pk_bf16_f32 v185, v146, v147
    v_cvt_pk_bf16_f32 v186, v148, v149
    v_cvt_pk_bf16_f32 v187, v150, v151
    s_mov_b32 s47, 0
    s_nop 0
    v_permlane16_swap_b32 v184, v186
    v_permlane16_swap_b32 v185, v187
    buffer_store_dwordx4 v[184:187], v7, s[36:39], s47 offen offset:768 sc1
    v_cvt_pk_bf16_f32 v188, v152, v153
    v_cvt_pk_bf16_f32 v189, v154, v155
    v_cvt_pk_bf16_f32 v190, v156, v157
    v_cvt_pk_bf16_f32 v191, v158, v159
    s_mov_b32 s47, 131072
    s_nop 0
    v_permlane16_swap_b32 v188, v190
    v_permlane16_swap_b32 v189, v191
    buffer_store_dwordx4 v[188:191], v7, s[36:39], s47 offen offset:768 sc1
    s_branch L_qj_49
L_qp_48:
    s_cmp_eq_u32 s27, 1
    s_cbranch_scc0 L_qg_50
    v_mfma_f32_16x16x32_bf16 v[96:99], v[64:67], v[80:83], v[96:99]
    v_mfma_f32_16x16x32_bf16 v[100:103], v[68:71], v[80:83], v[100:103]
    v_mfma_f32_16x16x32_bf16 v[104:107], v[72:75], v[80:83], v[104:107]
    v_mfma_f32_16x16x32_bf16 v[108:111], v[76:79], v[80:83], v[108:111]
    v_mfma_f32_16x16x32_bf16 v[112:115], v[64:67], v[84:87], v[112:115]
    v_mfma_f32_16x16x32_bf16 v[116:119], v[68:71], v[84:87], v[116:119]
    s_nop 3
    v_mfma_f32_16x16x32_bf16 v[120:123], v[72:75], v[84:87], v[120:123]
    v_mul_f32 v96, v3, v96
    v_mul_f32 v97, v3, v97
    v_mul_f32 v98, v3, v98
    v_mul_f32 v99, v3, v99
    v_mul_f32 v100, v3, v100
    v_mul_f32 v101, v3, v101
    v_mfma_f32_16x16x32_bf16 v[124:127], v[76:79], v[84:87], v[124:127]
    v_mul_f32 v102, v3, v102
    v_mul_f32 v103, v3, v103
    v_cvt_pk_bf16_f32 v160, v96, v97
    v_cvt_pk_bf16_f32 v161, v98, v99
    v_cvt_pk_bf16_f32 v162, v100, v101
    v_cvt_pk_bf16_f32 v163, v102, v103
    v_mfma_f32_16x16x32_bf16 v[128:131], v[32:35], v[56:59], v[128:131]
    s_mov_b32 s47, 0
    s_nop 0
    v_permlane16_swap_b32 v160, v162
    v_permlane16_swap_b32 v161, v163
    buffer_store_dwordx4 v[160:163], v7, s[36:39], s47 offen offset:0
    v_mul_f32 v104, v3, v104
    v_mul_f32 v105, v3, v105
    v_mfma_f32_16x16x32_bf16 v[132:135], v[36:39], v[56:59], v[132:135]
    v_mul_f32 v106, v3, v106
    v_mul_f32 v107, v3, v107
    v_mul_f32 v108, v3, v108
    v_mul_f32 v109, v3, v109
    v_mul_f32 v110, v3, v110
    v_mul_f32 v111, v3, v111
    v_mfma_f32_16x16x32_bf16 v[136:139], v[40:43], v[56:59], v[136:139]
    v_cvt_pk_bf16_f32 v164, v104, v105
    v_cvt_pk_bf16_f32 v165, v106, v107
    v_cvt_pk_bf16_f32 v166, v108, v109
    v_cvt_pk_bf16_f32 v167, v110, v111
    s_mov_b32 s47, 131072
    s_nop 0
    v_permlane16_swap_b32 v164, v166
    v_mfma_f32_16x16x32_bf16 v[140:143], v[44:47], v[56:59], v[140:143]
    v_permlane16_swap_b32 v165, v167
    buffer_store_dwordx4 v[164:167], v7, s[36:39], s47 offen offset:0
    v_mfma_f32_16x16x32_bf16 v[128:131], v[64:67], v[88:91], v[128:131]
    v_mfma_f32_16x16x32_bf16 v[132:135], v[68:71], v[88:91], v[132:135]
    s_nop 3
    v_mfma_f32_16x16x32_bf16 v[136:139], v[72:75], v[88:91], v[136:139]
    v_mul_f32 v112, v3, v112
    v_mul_f32 v113, v3, v113
    v_mul_f32 v114, v3, v114
    v_mul_f32 v115, v3, v115
    v_mul_f32 v116, v3, v116
    v_mul_f32 v117, v3, v117
    v_mfma_f32_16x16x32_bf16 v[140:143], v[76:79], v[88:91], v[140:143]
    v_mul_f32 v118, v3, v118
    v_mul_f32 v119, v3, v119
    v_cvt_pk_bf16_f32 v168, v112, v113
    v_cvt_pk_bf16_f32 v169, v114, v115
    v_cvt_pk_bf16_f32 v170, v116, v117
    v_cvt_pk_bf16_f32 v171, v118, v119
    v_mfma_f32_16x16x32_bf16 v[144:147], v[32:35], v[60:63], v[144:147]
    s_mov_b32 s47, 0
    s_nop 0
    v_permlane16_swap_b32 v168, v170
    v_permlane16_swap_b32 v169, v171
    buffer_store_dwordx4 v[168:171], v7, s[36:39], s47 offen offset:256
    v_mul_f32 v120, v3, v120
    v_mul_f32 v121, v3, v121
    v_mfma_f32_16x16x32_bf16 v[148:151], v[36:39], v[60:63], v[148:151]
    v_mul_f32 v122, v3, v122
    v_mul_f32 v123, v3, v123
    v_mul_f32 v124, v3, v124
    v_mul_f32 v125, v3, v125
    v_mul_f32 v126, v3, v126
    v_mul_f32 v127, v3, v127
    v_mfma_f32_16x16x32_bf16 v[152:155], v[40:43], v[60:63], v[152:155]
    v_cvt_pk_bf16_f32 v172, v120, v121
    v_cvt_pk_bf16_f32 v173, v122, v123
    v_cvt_pk_bf16_f32 v174, v124, v125
    v_cvt_pk_bf16_f32 v175, v126, v127
    s_mov_b32 s47, 131072
    s_nop 0
    v_permlane16_swap_b32 v172, v174
    v_mfma_f32_16x16x32_bf16 v[156:159], v[44:47], v[60:63], v[156:159]
    v_permlane16_swap_b32 v173, v175
    buffer_store_dwordx4 v[172:175], v7, s[36:39], s47 offen offset:256
    v_mfma_f32_16x16x32_bf16 v[144:147], v[64:67], v[92:95], v[144:147]
    v_mfma_f32_16x16x32_bf16 v[148:151], v[68:71], v[92:95], v[148:151]
    s_nop 3
    v_mfma_f32_16x16x32_bf16 v[152:155], v[72:75], v[92:95], v[152:155]
    v_mul_f32 v128, v3, v128
    v_mul_f32 v129, v3, v129
    v_mul_f32 v130, v3, v130
    v_mul_f32 v131, v3, v131
    v_mul_f32 v132, v3, v132
    v_mul_f32 v133, v3, v133
    v_mul_f32 v134, v3, v134
    v_mul_f32 v135, v3, v135
    v_cvt_pk_bf16_f32 v176, v128, v129
    v_cvt_pk_bf16_f32 v177, v130, v131
    v_cvt_pk_bf16_f32 v178, v132, v133
    v_cvt_pk_bf16_f32 v179, v134, v135
    s_mov_b32 s47, 0
    s_nop 0
    v_permlane16_swap_b32 v176, v178
    v_permlane16_swap_b32 v177, v179
    buffer_store_dwordx4 v[176:179], v7, s[36:39], s47 offen offset:512
    v_mfma_f32_16x16x32_bf16 v[156:159], v[76:79], v[92:95], v[156:159]
    v_mul_f32 v136, v3, v136
    v_mul_f32 v137, v3, v137
    v_mul_f32 v138, v3, v138
    v_mul_f32 v139, v3, v139
    v_mul_f32 v140, v3, v140
    v_mul_f32 v141, v3, v141
    v_mul_f32 v142, v3, v142
    v_mul_f32 v143, v3, v143
    v_cvt_pk_bf16_f32 v180, v136, v137
    v_cvt_pk_bf16_f32 v181, v138, v139
    v_cvt_pk_bf16_f32 v182, v140, v141
    v_cvt_pk_bf16_f32 v183, v142, v143
    s_mov_b32 s47, 131072
    s_nop 0
    v_permlane16_swap_b32 v180, v182
    v_permlane16_swap_b32 v181, v183
    buffer_store_dwordx4 v[180:183], v7, s[36:39], s47 offen offset:512
    s_nop 3
    v_mul_f32 v144, v3, v144
    v_mul_f32 v145, v3, v145
    v_mul_f32 v146, v3, v146
    v_mul_f32 v147, v3, v147
    v_mul_f32 v148, v3, v148
    v_mul_f32 v149, v3, v149
    v_mul_f32 v150, v3, v150
    v_mul_f32 v151, v3, v151
    v_cvt_pk_bf16_f32 v184, v144, v145
    v_cvt_pk_bf16_f32 v185, v146, v147
    v_cvt_pk_bf16_f32 v186, v148, v149
    v_cvt_pk_bf16_f32 v187, v150, v151
    s_mov_b32 s47, 0
    s_nop 0
    v_permlane16_swap_b32 v184, v186
    v_permlane16_swap_b32 v185, v187
    buffer_store_dwordx4 v[184:187], v7, s[36:39], s47 offen offset:768
    v_mul_f32 v152, v3, v152
    v_mul_f32 v153, v3, v153
    v_mul_f32 v154, v3, v154
    v_mul_f32 v155, v3, v155
    v_mul_f32 v156, v3, v156
    v_mul_f32 v157, v3, v157
    v_mul_f32 v158, v3, v158
    v_mul_f32 v159, v3, v159
    v_cvt_pk_bf16_f32 v188, v152, v153
    v_cvt_pk_bf16_f32 v189, v154, v155
    v_cvt_pk_bf16_f32 v190, v156, v157
    v_cvt_pk_bf16_f32 v191, v158, v159
    s_mov_b32 s47, 131072
    s_nop 0
    v_permlane16_swap_b32 v188, v190
    v_permlane16_swap_b32 v189, v191
    buffer_store_dwordx4 v[188:191], v7, s[36:39], s47 offen offset:768
L_qj_49:
    s_mov_b32 s52, s53
    s_setprio 0
    v_mov_b32 v13, 131072
    s_mul_i32 s47, s45, 5
    s_lshr_b32 s47, s47, 1
    s_and_b32 s51, s45, 1
    s_add_u32 s49, s47, s51
    s_lshl_b32 s48, s51, 1
    s_sub_u32 s50, s47, s48
    s_add_u32 s50, s50, 2
    s_lshl_b32 s100, s46, 1
    s_lshl_b32 s101, s46, 10
    v_and_b32 v8, 31, v1
    v_lshrrev_b32 v9, 5, v1
    v_lshlrev_b32 v10, 4, v8
    v_lshl_add_u32 v5, v9, 15, v10
    s_lshl_b32 s48, s100, 9
    v_add_u32 v10, s48, v10
    v_lshl_add_u32 v2, v9, 13, v10
    s_lshl_b32 s47, s51, 3
    s_add_u32 s47, s47, 16384
    v_add_u32 v3, s47, v10
    v_lshlrev_b32 v10, 2, v9
    v_sub_u32 v10, v8, v10
    v_cmp_le_i32 s[64:65], 0, v10
    v_cmp_le_i32 s[66:67], 1, v10
    v_cmp_le_i32 s[68:69], 2, v10
    v_cmp_le_i32 s[70:71], 3, v10
    v_cmp_le_i32 s[72:73], 8, v10
    v_cmp_le_i32 s[74:75], 9, v10
    v_cmp_le_i32 s[76:77], 10, v10
    v_cmp_le_i32 s[78:79], 11, v10
    v_cmp_le_i32 s[80:81], 16, v10
    v_cmp_le_i32 s[82:83], 17, v10
    v_cmp_le_i32 s[84:85], 18, v10
    v_cmp_le_i32 s[86:87], 19, v10
    v_cmp_le_i32 s[88:89], 24, v10
    v_cmp_le_i32 s[90:91], 25, v10
    v_cmp_le_i32 s[92:93], 26, v10
    v_cmp_le_i32 s[94:95], 27, v10
    v_mov_b32 v10, 0xffff
    v_mov_b32 v11, 0xffff0000
    v_cndmask_b32 v236, 0, v10, s[64:65]
    v_cndmask_b32 v12, 0, v11, s[66:67]
    v_or_b32 v236, v236, v12
    v_cndmask_b32 v237, 0, v10, s[68:69]
    v_cndmask_b32 v12, 0, v11, s[70:71]
    v_or_b32 v237, v237, v12
    v_cndmask_b32 v238, 0, v10, s[72:73]
    v_cndmask_b32 v12, 0, v11, s[74:75]
    v_or_b32 v238, v238, v12
    v_cndmask_b32 v239, 0, v10, s[76:77]
    v_cndmask_b32 v12, 0, v11, s[78:79]
    v_or_b32 v239, v239, v12
    v_cndmask_b32 v240, 0, v10, s[80:81]
    v_cndmask_b32 v12, 0, v11, s[82:83]
    v_or_b32 v240, v240, v12
    v_cndmask_b32 v241, 0, v10, s[84:85]
    v_cndmask_b32 v12, 0, v11, s[86:87]
    v_or_b32 v241, v241, v12
    v_cndmask_b32 v242, 0, v10, s[88:89]
    v_cndmask_b32 v12, 0, v11, s[90:91]
    v_or_b32 v242, v242, v12
    v_cndmask_b32 v243, 0, v10, s[92:93]
    v_cndmask_b32 v12, 0, v11, s[94:95]
    v_or_b32 v243, v243, v12
    v_sub_u32 v10, 1, v9
    v_mul_u32_u24 v10, 0x3f80, v10
    v_mov_b32 v34, v10
    v_mov_b32 v35, 0
    v_mov_b32 v42, v10
    v_mov_b32 v43, 0
    v_mov_b32 v50, v10
    v_mov_b32 v51, 0
    v_mov_b32 v58, v10
    v_mov_b32 v59, 0
    v_and_b32 v10, 3, v1
    v_lshrrev_b32 v11, 1, v10
    v_mul_u32_u24 v11, 8256, v11
    v_and_b32 v4, 1, v10
    v_lshl_add_u32 v11, v4, 3, v11
    s_lshl_b32 s47, s51, 3
    s_add_u32 s47, s47, 16512
    v_mov_b32 v4, 24768
    v_mov_b32 v12, s47
    v_cmp_eq_u32 s[54:55], 0, v10
    v_and_b32 v10, 16, v1
    s_nop 0
    v_cndmask_b32 v4, v4, v12, s[54:55]
    v_cmp_eq_u32 s[54:55], 0, v10
    v_bfe_u32 v10, v1, 2, 2
    v_lshl_add_u32 v10, v9, 2, v10
    v_cndmask_b32 v4, v4, v11, s[54:55]
    v_lshl_add_u32 v4, v10, 4, v4
    s_add_u32 s48, s48, 24576
    v_add_u32 v4, s48, v4
    v_mov_b32 v22, 0
    v_mov_b32 v23, 0
    v_mov_b32 v254, 0
    v_mov_b32 v255, 0
    s_branch L_gj_51
L_spl_4:
    v_mov_b32 v13, 131072
    s_mul_i32 s47, s45, 5
    s_lshr_b32 s47, s47, 1
    s_and_b32 s51, s45, 1
    s_add_u32 s49, s47, s51
    s_lshl_b32 s48, s51, 1
    s_sub_u32 s50, s47, s48
    s_add_u32 s50, s50, 2
    s_lshl_b32 s100, s46, 1
    s_lshl_b32 s101, s46, 10
    v_and_b32 v8, 31, v1
    v_lshrrev_b32 v9, 5, v1
    v_lshlrev_b32 v10, 4, v8
    v_lshl_add_u32 v5, v9, 15, v10
    s_lshl_b32 s48, s100, 9
    v_add_u32 v10, s48, v10
    v_lshl_add_u32 v2, v9, 13, v10
    s_lshl_b32 s47, s51, 3
    s_add_u32 s47, s47, 16384
    v_add_u32 v3, s47, v10
    v_lshlrev_b32 v10, 2, v9
    v_sub_u32 v10, v8, v10
    v_cmp_le_i32 s[64:65], 0, v10
    v_cmp_le_i32 s[66:67], 1, v10
    v_cmp_le_i32 s[68:69], 2, v10
    v_cmp_le_i32 s[70:71], 3, v10
    v_cmp_le_i32 s[72:73], 8, v10
    v_cmp_le_i32 s[74:75], 9, v10
    v_cmp_le_i32 s[76:77], 10, v10
    v_cmp_le_i32 s[78:79], 11, v10
    v_cmp_le_i32 s[80:81], 16, v10
    v_cmp_le_i32 s[82:83], 17, v10
    v_cmp_le_i32 s[84:85], 18, v10
    v_cmp_le_i32 s[86:87], 19, v10
    v_cmp_le_i32 s[88:89], 24, v10
    v_cmp_le_i32 s[90:91], 25, v10
    v_cmp_le_i32 s[92:93], 26, v10
    v_cmp_le_i32 s[94:95], 27, v10
    v_mov_b32 v10, 0xffff
    v_mov_b32 v11, 0xffff0000
    v_cndmask_b32 v236, 0, v10, s[64:65]
    v_cndmask_b32 v12, 0, v11, s[66:67]
    v_or_b32 v236, v236, v12
    v_cndmask_b32 v237, 0, v10, s[68:69]
    v_cndmask_b32 v12, 0, v11, s[70:71]
    v_or_b32 v237, v237, v12
    v_cndmask_b32 v238, 0, v10, s[72:73]
    v_cndmask_b32 v12, 0, v11, s[74:75]
    v_or_b32 v238, v238, v12
    v_cndmask_b32 v239, 0, v10, s[76:77]
    v_cndmask_b32 v12, 0, v11, s[78:79]
    v_or_b32 v239, v239, v12
    v_cndmask_b32 v240, 0, v10, s[80:81]
    v_cndmask_b32 v12, 0, v11, s[82:83]
    v_or_b32 v240, v240, v12
    v_cndmask_b32 v241, 0, v10, s[84:85]
    v_cndmask_b32 v12, 0, v11, s[86:87]
    v_or_b32 v241, v241, v12
    v_cndmask_b32 v242, 0, v10, s[88:89]
    v_cndmask_b32 v12, 0, v11, s[90:91]
    v_or_b32 v242, v242, v12
    v_cndmask_b32 v243, 0, v10, s[92:93]
    v_cndmask_b32 v12, 0, v11, s[94:95]
    v_or_b32 v243, v243, v12
    v_sub_u32 v10, 1, v9
    v_mul_u32_u24 v10, 0x3f80, v10
    v_mov_b32 v34, v10
    v_mov_b32 v35, 0
    v_mov_b32 v42, v10
    v_mov_b32 v43, 0
    v_mov_b32 v50, v10
    v_mov_b32 v51, 0
    v_mov_b32 v58, v10
    v_mov_b32 v59, 0
    v_and_b32 v10, 3, v1
    v_lshrrev_b32 v11, 1, v10
    v_mul_u32_u24 v11, 8256, v11
    v_and_b32 v4, 1, v10
    v_lshl_add_u32 v11, v4, 3, v11
    s_lshl_b32 s47, s51, 3
    s_add_u32 s47, s47, 16512
    v_mov_b32 v4, 24768
    v_mov_b32 v12, s47
    v_cmp_eq_u32 s[54:55], 0, v10
    v_and_b32 v10, 16, v1
    s_nop 0
    v_cndmask_b32 v4, v4, v12, s[54:55]
    v_cmp_eq_u32 s[54:55], 0, v10
    v_bfe_u32 v10, v1, 2, 2
    v_lshl_add_u32 v10, v9, 2, v10
    v_cndmask_b32 v4, v4, v11, s[54:55]
    v_lshl_add_u32 v4, v10, 4, v4
    s_add_u32 s48, s48, 24576
    v_add_u32 v4, s48, v4
    v_mov_b32 v22, 0
    v_mov_b32 v23, 0
    v_mov_b32 v254, 0
    v_mov_b32 v255, 0
L_gj_51:
    v_lshlrev_b32 v8, 4, v0
    s_cmp_eq_u32 s44, 0
    s_cselect_b32 s47, 0, 0x3f80
    v_mov_b32 v10, s47
    v_mov_b32 v11, 0
    ds_write_b64 v8, v[10:11] offset:49344
    v_mov_b32 v10, 0x3f80
    ds_write_b64 v8, v[10:11] offset:53440
    s_min_u32 s47, s49, s50
    s_add_u32 s48, s47, 2
    v_lshrrev_b32 v9, 2, v1
    v_cmp_le_u32 s[54:55], 3, v9
    v_subrev_u32 v10, 2, v9
    v_and_b32 v8, 2, v1
    v_cndmask_b32 v9, v9, v10, s[54:55]
    v_mul_u32_u24 v9, 80, v9
    v_add3_u32 v9, v9, v8, s47
    v_lshrrev_b32 v9, 4, v9
    v_and_b32 v8, 1, v1
    v_mul_u32_u24 v8, 15, v8
    v_add_u32 v8, v8, v9
    v_lshl_add_u32 v8, v8, 3, s44
    v_subrev_u32 v9, 1, v8
    v_cndmask_b32 v8, v8, v9, s[54:55]
    v_lshlrev_b32 v8, 7, v8
    s_cmp_eq_u32 s44, 0
    s_cselect_b32 s47, 12, 20
    v_cmp_gt_u32 s[54:55], s47, v1
    v_readfirstlane_b32 s47, v8
    s_mov_b32 s56, s36
    s_mov_b32 s57, s37
    s_cselect_b32 s58, 0, 16777216
    s_mov_b32 s59, 0x20000
    v_mov_b32 v9, s47
    v_cndmask_b32 v8, v9, v8, s[54:55]
    s_lshl_b32 s47, s2, 7
    s_add_u32 s47, s47, 14680064
    v_mov_b32 v9, s47
    v_mov_b32 v10, s26
    s_lshl_b32 s53, s99, 19
    s_lshl_b32 s48, s98, 11
    s_add_u32 s53, s53, s48
    v_lshrrev_b32 v11, 4, v1
    v_lshlrev_b32 v11, 15, v11
    v_and_b32 v24, 15, v1
    v_lshl_add_u32 v11, v24, 7, v11
    s_waitcnt vmcnt(0)
    s_lshl_b32 s47, s46, 2
    v_add_u32 v17, s47, v13
    s_mov_b64 exec, 1
    v_mov_b32 v16, 1
    ds_write_b32 v17, v16 offset:32256
    s_mov_b64 exec, -1
    s_cmp_lg_u32 s46, 0
    s_cbranch_scc1 L_f1_53
    s_cmp_ge_u32 s45, 30
    s_cbranch_scc1 L_f0_52
    s_mov_b32 s48, 0
L_ww_55:
    ds_read_b128 v[16:19], v13 offset:32256
    s_waitcnt lgkmcnt(0)
    v_and_b32 v16, v16, v17
    v_and_b32 v18, v18, v19
    v_and_b32 v16, v16, v18
    v_cmp_ne_u32 vcc, 1, v16
    s_cbranch_vccz L_wwd_56
    s_add_u32 s48, s48, 1
    s_cmp_lt_u32 s48, 0x400000
    s_cbranch_scc1 L_ww_55
L_wwd_56:
    s_mov_b64 exec, 1
    buffer_store_dword v10, v9, s[36:39], 0 offen sc1
    s_mov_b64 exec, -1
    buffer_load_dword v108, v11, s[36:39], s53 offen sc1
    s_add_u32 s53, s53, 131072
    buffer_load_dword v109, v11, s[36:39], s53 offen sc1
    s_add_u32 s53, s53, 131072
    buffer_load_dword v110, v11, s[36:39], s53 offen sc1
    s_add_u32 s53, s53, 131072
    buffer_load_dword v111, v11, s[36:39], s53 offen sc1
    s_add_u32 s53, s53, 131072
L_f0_52:
    s_mov_b32 s47, 0
    s_mov_b32 s48, 14680064
L_poll_57:
    buffer_load_dword v9, v8, s[36:39], s48 offen sc1
    s_waitcnt vmcnt(0)
    v_xor_b32 v9, s26, v9
    v_cmp_ne_u32 vcc, 0, v9
    s_cbranch_vccz L_polld_58
    s_add_u32 s47, s47, 1
    s_cmp_lt_u32 s47, 0x100000
    s_cbranch_scc1 L_poll_57
L_polld_58:
    s_mov_b64 exec, 1
    v_mov_b32 v16, 1
    ds_write_b32 v13, v16 offset:32272
    s_mov_b64 exec, -1
    s_branch L_go_54
L_f1_53:
    s_mov_b32 s48, 0
L_ww_59:
    ds_read_b32 v16, v13 offset:32272
    s_waitcnt lgkmcnt(0)
    v_cmp_ne_u32 vcc, 1, v16
    s_cbranch_vccz L_wwd_60
    s_add_u32 s48, s48, 1
    s_cmp_lt_u32 s48, 0x400000
    s_cbranch_scc1 L_ww_59
L_wwd_60:
L_go_54:
    s_lshl_b32 s47, s44, 2
    s_add_u32 s47, s47, s46
    s_lshl_b32 s47, s47, 10
    v_lshl_add_u32 v8, v1, 4, s47
    v_subrev_u32 v9, 4096, v8
    s_add_u32 s47, s49, 80
    s_add_u32 m0, s101, 0
    s_lshl_b32 s47, s47, 15
    buffer_load_dwordx4 v9, s[56:59], s47 offen sc1 lds
    s_add_u32 s47, s49, 81
    s_add_u32 m0, s101, 8192
    s_lshl_b32 s47, s47, 15
    buffer_load_dwordx4 v9, s[56:59], s47 offen sc1 lds
    s_add_u32 s47, s50, 80
    s_add_u32 m0, s101, 16384
    s_lshl_b32 s47, s47, 15
    buffer_load_dwordx4 v9, s[56:59], s47 offen sc1 lds
    s_add_u32 s47, s49, 160
    s_add_u32 m0, s101, 24576
    s_lshl_b32 s47, s47, 15
    buffer_load_dwordx4 v9, s[56:59], s47 offen sc1 lds
    s_add_u32 s47, s49, 161
    s_add_u32 m0, s101, 32832
    s_lshl_b32 s47, s47, 15
    buffer_load_dwordx4 v9, s[56:59], s47 offen sc1 lds
    s_add_u32 s47, s50, 160
    s_add_u32 m0, s101, 41088
    s_lshl_b32 s47, s47, 15
    buffer_load_dwordx4 v9, s[56:59], s47 offen sc1 lds
    s_add_u32 s47, s49, 80
    s_add_u32 m0, s101, 4096
    s_lshl_b32 s47, s47, 15
    buffer_load_dwordx4 v8, s[36:39], s47 offen sc1 lds
    s_add_u32 s47, s49, 81
    s_add_u32 m0, s101, 12288
    s_lshl_b32 s47, s47, 15
    buffer_load_dwordx4 v8, s[36:39], s47 offen sc1 lds
    s_add_u32 s47, s50, 80
    s_add_u32 m0, s101, 20480
    s_lshl_b32 s47, s47, 15
    buffer_load_dwordx4 v8, s[36:39], s47 offen sc1 lds
    s_add_u32 s47, s49, 160
    s_add_u32 m0, s101, 28672
    s_lshl_b32 s47, s47, 15
    buffer_load_dwordx4 v8, s[36:39], s47 offen sc1 lds
    s_add_u32 s47, s49, 161
    s_add_u32 m0, s101, 36928
    s_lshl_b32 s47, s47, 15
    buffer_load_dwordx4 v8, s[36:39], s47 offen sc1 lds
    s_add_u32 s47, s50, 160
    s_add_u32 m0, s101, 45184
    s_lshl_b32 s47, s47, 15
    buffer_load_dwordx4 v8, s[36:39], s47 offen sc1 lds
    s_lshl_b32 s47, s44, 3
    s_add_u32 s48, s47, s100
    s_lshl_b32 s48, s48, 9
    v_add_u32 v5, s48, v5
    s_lshl_b32 s47, s49, 15
    buffer_load_dwordx4 v[16:19], v5, s[36:39], s47 offen sc1
    buffer_load_dwordx4 v[248:251], v5, s[36:39], s47 offen offset:512 sc1
    v_and_b32 v10, 0x7fff, v5
    s_lshl_b32 s47, s50, 15
    s_lshl_b32 s48, s51, 3
    s_add_u32 s48, s48, s47
    buffer_load_dwordx2 v[20:21], v10, s[36:39], s48 offen sc1
    buffer_load_dwordx2 v[252:253], v10, s[36:39], s48 offen offset:512 sc1
    s_lshl_b32 s47, s46, 2
    v_add_u32 v9, s47, v13
    s_mov_b64 exec, 1
    v_mov_b32 v8, 1
    ds_write_b32 v9, v8 offset:32352
    s_mov_b64 exec, -1
    s_mul_i32 s47, s45, 5
    s_add_u32 s48, s47, s51
    v_lshrrev_b32 v9, 5, v1
    v_and_b32 v8, 0x7fff, v5
    s_cmp_eq_u32 s51, 0
    s_cselect_b32 s53, 4, 0
    s_add_u32 s47, s47, s53
    s_lshl_b32 s47, s49, 15
    v_add_u32 v7, s47, v5
    s_lshl_b32 s47, s50, 15
    s_lshl_b32 s48, s51, 3
    s_add_u32 s47, s47, s48
    v_add_u32 v244, s47, v8
    s_waitcnt vmcnt(0) lgkmcnt(0)
    s_lshl_b32 s47, s46, 2
    v_add_u32 v9, s47, v13
    s_mov_b64 exec, 1
    v_mov_b32 v8, 1
    ds_write_b32 v9, v8 offset:32304
    s_mov_b64 exec, -1
    s_mov_b32 s48, 0
L_ww_61:
    ds_read_b128 v[8:11], v13 offset:32304
    s_waitcnt lgkmcnt(0)
    v_and_b32 v8, v8, v9
    v_and_b32 v10, v10, v11
    v_and_b32 v8, v8, v10
    v_cmp_ne_u32 vcc, 1, v8
    s_cbranch_vccz L_wwd_62
    s_add_u32 s48, s48, 1
    s_cmp_lt_u32 s48, 0x400000
    s_cbranch_scc1 L_ww_61
L_wwd_62:
L_att_5:
    s_setprio 1
    ds_read_b128 v[28:31], v2 offset:3584
    ds_read_b64 v[32:33], v3 offset:3584
    ds_read_b128 v[36:39], v2 offset:3072
    ds_read_b64 v[40:41], v3 offset:3072
    ds_read_b64_tr_b16 v[60:61], v4 offset:3584
    ds_read_b64_tr_b16 v[62:63], v4 offset:3712
    ds_read_b64_tr_b16 v[64:65], v4 offset:3840
    ds_read_b64_tr_b16 v[66:67], v4 offset:3968
    s_mov_b32 exec_lo, 0
    v_mov_b32 v20, 0
    v_mov_b32 v21, 0
    v_mov_b32 v252, 0
    v_mov_b32 v253, 0
    s_mov_b32 exec_lo, -1
    s_waitcnt lgkmcnt(6)
    v_mfma_f32_32x32x16_bf16 v[108:123], v[28:31], v[16:19], 0
    v_mfma_f32_32x32x16_bf16 v[108:123], v[32:35], v[20:23], v[108:123]
    v_mov_b32 v92, 0
    v_mov_b32 v93, 0
    v_mov_b32 v95, 0
    v_mov_b32 v100, 0
    v_mov_b32 v101, 0
    v_mov_b32 v103, 0
    v_mfma_f32_32x32x16_bf16 v[156:171], v[28:31], v[248:251], 0
    ds_read_b128 v[44:47], v2 offset:4096
    ds_read_b64 v[48:49], v3 offset:4096
    ds_read_b128 v[52:55], v2 offset:4608
    ds_read_b64 v[56:57], v3 offset:4608
    v_mfma_f32_32x32x16_bf16 v[156:171], v[32:35], v[252:255], v[156:171]
    v_max3_f32 v8, v108, v109, v110
    v_max3_f32 v9, v111, v112, v113
    v_max3_f32 v10, v114, v115, v116
    v_max3_f32 v11, v117, v118, v119
    v_max3_f32 v8, v8, v120, v121
    v_max3_f32 v9, v9, v122, v123
    v_max3_f32 v8, v8, v10, v11
    v_max_f32 v8, v8, v9
    v_mov_b32 v9, v8
    s_nop 1
    v_permlane32_swap_b32 v8, v9
    v_max_f32 v8, v8, v9
    v_sub_f32 v8, 3257925632, v8
    v_cvt_pk_bf16_f32 v22, v8, 0
    v_mov_b32 v94, v22
    v_max3_f32 v24, v156, v157, v158
    v_max3_f32 v25, v159, v160, v161
    v_mfma_f32_32x32x16_bf16 v[108:123], v[32:35], v[92:95], v[108:123]
    v_max3_f32 v26, v162, v163, v164
    v_max3_f32 v27, v165, v166, v167
    v_max3_f32 v24, v24, v168, v169
    v_max3_f32 v25, v25, v170, v171
    v_max3_f32 v24, v24, v26, v27
    v_max_f32 v24, v24, v25
    v_mov_b32 v25, v24
    s_waitcnt lgkmcnt(8)
    v_mfma_f32_32x32x16_bf16 v[124:139], v[36:39], v[16:19], 0
    v_permlane32_swap_b32 v24, v25
    v_max_f32 v24, v24, v25
    v_sub_f32 v24, 3257925632, v24
    v_cvt_pk_bf16_f32 v254, v24, 0
    v_mov_b32 v102, v254
    ds_read_b64_tr_b16 v[76:77], v4 offset:4096
    ds_read_b64_tr_b16 v[78:79], v4 offset:4224
    v_mfma_f32_32x32x16_bf16 v[124:139], v[40:43], v[20:23], v[124:139]
    ds_read_b64_tr_b16 v[80:81], v4 offset:4352
    ds_read_b64_tr_b16 v[82:83], v4 offset:4480
    ds_read_b64_tr_b16 v[68:69], v4 offset:3072
    ds_read_b64_tr_b16 v[70:71], v4 offset:3200
    ds_read_b64_tr_b16 v[72:73], v4 offset:3328
    ds_read_b64_tr_b16 v[74:75], v4 offset:3456
    v_mfma_f32_32x32x16_bf16 v[156:171], v[32:35], v[100:103], v[156:171]
    v_exp_f32 v108, v108
    v_exp_f32 v109, v109
    v_exp_f32 v110, v110
    v_exp_f32 v111, v111
    v_cvt_pk_bf16_f32 v92, v108, v109
    v_exp_f32 v112, v112
    v_exp_f32 v113, v113
    v_exp_f32 v114, v114
    v_exp_f32 v115, v115
    v_cvt_pk_bf16_f32 v93, v110, v111
    v_cvt_pk_bf16_f32 v94, v112, v113
    v_cvt_pk_bf16_f32 v95, v114, v115
    v_exp_f32 v116, v116
    v_exp_f32 v117, v117
    v_exp_f32 v118, v118
    v_exp_f32 v119, v119
    s_waitcnt lgkmcnt(8)
    v_mfma_f32_32x32x16_bf16 v[204:219], v[60:63], v[92:95], 0
    v_exp_f32 v120, v120
    v_exp_f32 v121, v121
    v_exp_f32 v122, v122
    v_exp_f32 v123, v123
    v_cvt_pk_bf16_f32 v96, v116, v117
    v_cvt_pk_bf16_f32 v97, v118, v119
    v_cvt_pk_bf16_f32 v98, v120, v121
    v_cvt_pk_bf16_f32 v99, v122, v123
    ds_read_b128 v[28:31], v2 offset:2560
    ds_read_b64 v[32:33], v3 offset:2560
    v_mfma_f32_32x32x16_bf16 v[204:219], v[64:67], v[96:99], v[204:219]
    v_exp_f32 v156, v156
    v_exp_f32 v157, v157
    v_exp_f32 v158, v158
    v_exp_f32 v159, v159
    v_cvt_pk_bf16_f32 v100, v156, v157
    v_mfma_f32_32x32x16_bf16 v[172:187], v[36:39], v[248:251], 0
    v_exp_f32 v160, v160
    v_exp_f32 v161, v161
    v_exp_f32 v162, v162
    v_exp_f32 v163, v163
    v_cvt_pk_bf16_f32 v101, v158, v159
    v_mfma_f32_32x32x16_bf16 v[172:187], v[40:43], v[252:255], v[172:187]
    v_cvt_pk_bf16_f32 v102, v160, v161
    v_cvt_pk_bf16_f32 v103, v162, v163
    v_exp_f32 v164, v164
    v_exp_f32 v165, v165
    v_exp_f32 v166, v166
    v_exp_f32 v167, v167
    v_mfma_f32_32x32x16_bf16 v[220:235], v[60:63], v[100:103], 0
    v_exp_f32 v168, v168
    v_exp_f32 v169, v169
    v_exp_f32 v170, v170
    v_exp_f32 v171, v171
    v_cvt_pk_bf16_f32 v104, v164, v165
    v_cvt_pk_bf16_f32 v105, v166, v167
    v_cvt_pk_bf16_f32 v106, v168, v169
    v_cvt_pk_bf16_f32 v107, v170, v171
    s_waitcnt lgkmcnt(0)
    s_nop 0
    v_mfma_f32_32x32x16_bf16 v[220:235], v[64:67], v[104:107], v[220:235]
    ds_read_b64_tr_b16 v[60:61], v4 offset:2560
    ds_read_b64_tr_b16 v[62:63], v4 offset:2688
    ds_read_b64_tr_b16 v[84:85], v4 offset:4608
    ds_read_b64_tr_b16 v[86:87], v4 offset:4736
    v_exp_f32 v124, v124
    v_exp_f32 v125, v125
    v_exp_f32 v126, v126
    v_exp_f32 v127, v127
    v_cvt_pk_bf16_f32 v92, v124, v125
    v_mfma_f32_32x32x16_bf16 v[108:123], v[28:31], v[16:19], 0
    ds_read_b64_tr_b16 v[64:65], v4 offset:2816
    ds_read_b64_tr_b16 v[66:67], v4 offset:2944
    ds_read_b64_tr_b16 v[88:89], v4 offset:4864
    ds_read_b64_tr_b16 v[90:91], v4 offset:4992
    v_exp_f32 v128, v128
    v_exp_f32 v129, v129
    v_exp_f32 v130, v130
    v_exp_f32 v131, v131
    v_cvt_pk_bf16_f32 v93, v126, v127
    v_mfma_f32_32x32x16_bf16 v[108:123], v[32:35], v[20:23], v[108:123]
    v_cvt_pk_bf16_f32 v94, v128, v129
    v_cvt_pk_bf16_f32 v95, v130, v131
    v_exp_f32 v132, v132
    v_exp_f32 v133, v133
    v_exp_f32 v134, v134
    v_exp_f32 v135, v135
    v_mfma_f32_32x32x16_bf16 v[204:219], v[68:71], v[92:95], v[204:219]
    v_exp_f32 v136, v136
    v_exp_f32 v137, v137
    v_exp_f32 v138, v138
    v_exp_f32 v139, v139
    v_cvt_pk_bf16_f32 v96, v132, v133
    v_cvt_pk_bf16_f32 v97, v134, v135
    v_cvt_pk_bf16_f32 v98, v136, v137
    v_cvt_pk_bf16_f32 v99, v138, v139
    ds_read_b128 v[36:39], v2 offset:2048
    ds_read_b64 v[40:41], v3 offset:2048
    v_mfma_f32_32x32x16_bf16 v[204:219], v[72:75], v[96:99], v[204:219]
    v_exp_f32 v172, v172
    v_exp_f32 v173, v173
    v_exp_f32 v174, v174
    v_exp_f32 v175, v175
    v_cvt_pk_bf16_f32 v100, v172, v173
    v_mfma_f32_32x32x16_bf16 v[156:171], v[28:31], v[248:251], 0
    v_exp_f32 v176, v176
    v_exp_f32 v177, v177
    v_exp_f32 v178, v178
    v_exp_f32 v179, v179
    v_cvt_pk_bf16_f32 v101, v174, v175
    v_mfma_f32_32x32x16_bf16 v[156:171], v[32:35], v[252:255], v[156:171]
    v_cvt_pk_bf16_f32 v102, v176, v177
    v_cvt_pk_bf16_f32 v103, v178, v179
    v_exp_f32 v180, v180
    v_exp_f32 v181, v181
    v_exp_f32 v182, v182
    v_exp_f32 v183, v183
    v_mfma_f32_32x32x16_bf16 v[220:235], v[68:71], v[100:103], v[220:235]
    v_exp_f32 v184, v184
    v_exp_f32 v185, v185
    v_exp_f32 v186, v186
    v_exp_f32 v187, v187
    v_cvt_pk_bf16_f32 v104, v180, v181
    v_cvt_pk_bf16_f32 v105, v182, v183
    v_cvt_pk_bf16_f32 v106, v184, v185
    v_cvt_pk_bf16_f32 v107, v186, v187
    s_waitcnt lgkmcnt(0)
    s_nop 0
    v_mfma_f32_32x32x16_bf16 v[220:235], v[72:75], v[104:107], v[220:235]
    ds_read_b64_tr_b16 v[68:69], v4 offset:2048
    ds_read_b64_tr_b16 v[70:71], v4 offset:2176
    v_exp_f32 v108, v108
    v_exp_f32 v109, v109
    v_exp_f32 v110, v110
    v_exp_f32 v111, v111
    v_cvt_pk_bf16_f32 v92, v108, v109
    v_mfma_f32_32x32x16_bf16 v[124:139], v[36:39], v[16:19], 0
    ds_read_b64_tr_b16 v[72:73], v4 offset:2304
    ds_read_b64_tr_b16 v[74:75], v4 offset:2432
    v_exp_f32 v112, v112
    v_exp_f32 v113, v113
    v_exp_f32 v114, v114
    v_exp_f32 v115, v115
    v_cvt_pk_bf16_f32 v93, v110, v111
    v_mfma_f32_32x32x16_bf16 v[124:139], v[40:43], v[20:23], v[124:139]
    v_cvt_pk_bf16_f32 v94, v112, v113
    v_cvt_pk_bf16_f32 v95, v114, v115
    v_exp_f32 v116, v116
    v_exp_f32 v117, v117
    v_exp_f32 v118, v118
    v_exp_f32 v119, v119
    v_mfma_f32_32x32x16_bf16 v[204:219], v[60:63], v[92:95], v[204:219]
    v_exp_f32 v120, v120
    v_exp_f32 v121, v121
    v_exp_f32 v122, v122
    v_exp_f32 v123, v123
    v_cvt_pk_bf16_f32 v96, v116, v117
    v_cvt_pk_bf16_f32 v97, v118, v119
    v_cvt_pk_bf16_f32 v98, v120, v121
    v_cvt_pk_bf16_f32 v99, v122, v123
    ds_read_b128 v[28:31], v2 offset:1536
    ds_read_b64 v[32:33], v3 offset:1536
    v_mfma_f32_32x32x16_bf16 v[204:219], v[64:67], v[96:99], v[204:219]
    v_exp_f32 v156, v156
    v_exp_f32 v157, v157
    v_exp_f32 v158, v158
    v_exp_f32 v159, v159
    v_cvt_pk_bf16_f32 v100, v156, v157
    v_mfma_f32_32x32x16_bf16 v[172:187], v[36:39], v[248:251], 0
    v_exp_f32 v160, v160
    v_exp_f32 v161, v161
    v_exp_f32 v162, v162
    v_exp_f32 v163, v163
    v_cvt_pk_bf16_f32 v101, v158, v159
    v_mfma_f32_32x32x16_bf16 v[172:187], v[40:43], v[252:255], v[172:187]
    v_cvt_pk_bf16_f32 v102, v160, v161
    v_cvt_pk_bf16_f32 v103, v162, v163
    v_exp_f32 v164, v164
    v_exp_f32 v165, v165
    v_exp_f32 v166, v166
    v_exp_f32 v167, v167
    v_mfma_f32_32x32x16_bf16 v[220:235], v[60:63], v[100:103], v[220:235]
    v_exp_f32 v168, v168
    v_exp_f32 v169, v169
    v_exp_f32 v170, v170
    v_exp_f32 v171, v171
    v_cvt_pk_bf16_f32 v104, v164, v165
    v_cvt_pk_bf16_f32 v105, v166, v167
    v_cvt_pk_bf16_f32 v106, v168, v169
    v_cvt_pk_bf16_f32 v107, v170, v171
    s_waitcnt lgkmcnt(0)
    s_nop 0
    v_mfma_f32_32x32x16_bf16 v[220:235], v[64:67], v[104:107], v[220:235]
    ds_read_b64_tr_b16 v[60:61], v4 offset:1536
    ds_read_b64_tr_b16 v[62:63], v4 offset:1664
    v_exp_f32 v124, v124
    v_exp_f32 v125, v125
    v_exp_f32 v126, v126
    v_exp_f32 v127, v127
    v_cvt_pk_bf16_f32 v92, v124, v125
    v_mfma_f32_32x32x16_bf16 v[108:123], v[28:31], v[16:19], 0
    ds_read_b64_tr_b16 v[64:65], v4 offset:1792
    ds_read_b64_tr_b16 v[66:67], v4 offset:1920
    v_exp_f32 v128, v128
    v_exp_f32 v129, v129
    v_exp_f32 v130, v130
    v_exp_f32 v131, v131
    v_cvt_pk_bf16_f32 v93, v126, v127
    v_mfma_f32_32x32x16_bf16 v[108:123], v[32:35], v[20:23], v[108:123]
    v_cvt_pk_bf16_f32 v94, v128, v129
    v_cvt_pk_bf16_f32 v95, v130, v131
    v_exp_f32 v132, v132
    v_exp_f32 v133, v133
    v_exp_f32 v134, v134
    v_exp_f32 v135, v135
    v_mfma_f32_32x32x16_bf16 v[204:219], v[68:71], v[92:95], v[204:219]
    v_exp_f32 v136, v136
    v_exp_f32 v137, v137
    v_exp_f32 v138, v138
    v_exp_f32 v139, v139
    v_cvt_pk_bf16_f32 v96, v132, v133
    v_cvt_pk_bf16_f32 v97, v134, v135
    v_cvt_pk_bf16_f32 v98, v136, v137
    v_cvt_pk_bf16_f32 v99, v138, v139
    ds_read_b128 v[36:39], v2 offset:1024
    ds_read_b64 v[40:41], v3 offset:1024
    v_mfma_f32_32x32x16_bf16 v[204:219], v[72:75], v[96:99], v[204:219]
    v_exp_f32 v172, v172
    v_exp_f32 v173, v173
    v_exp_f32 v174, v174
    v_exp_f32 v175, v175
    v_cvt_pk_bf16_f32 v100, v172, v173
    v_mfma_f32_32x32x16_bf16 v[156:171], v[28:31], v[248:251], 0
    v_exp_f32 v176, v176
    v_exp_f32 v177, v177
    v_exp_f32 v178, v178
    v_exp_f32 v179, v179
    v_cvt_pk_bf16_f32 v101, v174, v175
    v_mfma_f32_32x32x16_bf16 v[156:171], v[32:35], v[252:255], v[156:171]
    v_cvt_pk_bf16_f32 v102, v176, v177
    v_cvt_pk_bf16_f32 v103, v178, v179
    v_exp_f32 v180, v180
    v_exp_f32 v181, v181
    v_exp_f32 v182, v182
    v_exp_f32 v183, v183
    v_mfma_f32_32x32x16_bf16 v[220:235], v[68:71], v[100:103], v[220:235]
    v_exp_f32 v184, v184
    v_exp_f32 v185, v185
    v_exp_f32 v186, v186
    v_exp_f32 v187, v187
    v_cvt_pk_bf16_f32 v104, v180, v181
    v_cvt_pk_bf16_f32 v105, v182, v183
    v_cvt_pk_bf16_f32 v106, v184, v185
    v_cvt_pk_bf16_f32 v107, v186, v187
    s_waitcnt lgkmcnt(0)
    s_nop 0
    v_mfma_f32_32x32x16_bf16 v[220:235], v[72:75], v[104:107], v[220:235]
    ds_read_b64_tr_b16 v[68:69], v4 offset:1024
    ds_read_b64_tr_b16 v[70:71], v4 offset:1152
    v_exp_f32 v108, v108
    v_exp_f32 v109, v109
    v_exp_f32 v110, v110
    v_exp_f32 v111, v111
    v_cvt_pk_bf16_f32 v92, v108, v109
    v_mfma_f32_32x32x16_bf16 v[124:139], v[36:39], v[16:19], 0
    ds_read_b64_tr_b16 v[72:73], v4 offset:1280
    ds_read_b64_tr_b16 v[74:75], v4 offset:1408
    v_exp_f32 v112, v112
    v_exp_f32 v113, v113
    v_exp_f32 v114, v114
    v_exp_f32 v115, v115
    v_cvt_pk_bf16_f32 v93, v110, v111
    v_mfma_f32_32x32x16_bf16 v[124:139], v[40:43], v[20:23], v[124:139]
    v_cvt_pk_bf16_f32 v94, v112, v113
    v_cvt_pk_bf16_f32 v95, v114, v115
    v_exp_f32 v116, v116
    v_exp_f32 v117, v117
    v_exp_f32 v118, v118
    v_exp_f32 v119, v119
    v_mfma_f32_32x32x16_bf16 v[204:219], v[60:63], v[92:95], v[204:219]
    v_exp_f32 v120, v120
    v_exp_f32 v121, v121
    v_exp_f32 v122, v122
    v_exp_f32 v123, v123
    v_cvt_pk_bf16_f32 v96, v116, v117
    v_cvt_pk_bf16_f32 v97, v118, v119
    v_cvt_pk_bf16_f32 v98, v120, v121
    v_cvt_pk_bf16_f32 v99, v122, v123
    ds_read_b128 v[28:31], v2 offset:512
    ds_read_b64 v[32:33], v3 offset:512
    v_mfma_f32_32x32x16_bf16 v[204:219], v[64:67], v[96:99], v[204:219]
    v_exp_f32 v156, v156
    v_exp_f32 v157, v157
    v_exp_f32 v158, v158
    v_exp_f32 v159, v159
    v_cvt_pk_bf16_f32 v100, v156, v157
    v_mfma_f32_32x32x16_bf16 v[172:187], v[36:39], v[248:251], 0
    v_exp_f32 v160, v160
    v_exp_f32 v161, v161
    v_exp_f32 v162, v162
    v_exp_f32 v163, v163
    v_cvt_pk_bf16_f32 v101, v158, v159
    v_mfma_f32_32x32x16_bf16 v[172:187], v[40:43], v[252:255], v[172:187]
    v_cvt_pk_bf16_f32 v102, v160, v161
    v_cvt_pk_bf16_f32 v103, v162, v163
    v_exp_f32 v164, v164
    v_exp_f32 v165, v165
    v_exp_f32 v166, v166
    v_exp_f32 v167, v167
    v_mfma_f32_32x32x16_bf16 v[220:235], v[60:63], v[100:103], v[220:235]
    v_exp_f32 v168, v168
    v_exp_f32 v169, v169
    v_exp_f32 v170, v170
    v_exp_f32 v171, v171
    v_cvt_pk_bf16_f32 v104, v164, v165
    v_cvt_pk_bf16_f32 v105, v166, v167
    v_cvt_pk_bf16_f32 v106, v168, v169
    v_cvt_pk_bf16_f32 v107, v170, v171
    s_waitcnt lgkmcnt(0)
    s_nop 0
    v_mfma_f32_32x32x16_bf16 v[220:235], v[64:67], v[104:107], v[220:235]
    ds_read_b64_tr_b16 v[60:61], v4 offset:512
    ds_read_b64_tr_b16 v[62:63], v4 offset:640
    v_exp_f32 v124, v124
    v_exp_f32 v125, v125
    v_exp_f32 v126, v126
    v_exp_f32 v127, v127
    v_cvt_pk_bf16_f32 v92, v124, v125
    v_mfma_f32_32x32x16_bf16 v[108:123], v[28:31], v[16:19], 0
    ds_read_b64_tr_b16 v[64:65], v4 offset:768
    ds_read_b64_tr_b16 v[66:67], v4 offset:896
    v_exp_f32 v128, v128
    v_exp_f32 v129, v129
    v_exp_f32 v130, v130
    v_exp_f32 v131, v131
    v_cvt_pk_bf16_f32 v93, v126, v127
    v_mfma_f32_32x32x16_bf16 v[108:123], v[32:35], v[20:23], v[108:123]
    v_cvt_pk_bf16_f32 v94, v128, v129
    v_cvt_pk_bf16_f32 v95, v130, v131
    v_exp_f32 v132, v132
    v_exp_f32 v133, v133
    v_exp_f32 v134, v134
    v_exp_f32 v135, v135
    v_mfma_f32_32x32x16_bf16 v[204:219], v[68:71], v[92:95], v[204:219]
    v_exp_f32 v136, v136
    v_exp_f32 v137, v137
    v_cvt_pk_bf16_f32 v96, v132, v133
    v_cvt_pk_bf16_f32 v97, v134, v135
    v_exp_f32 v138, v138
    v_exp_f32 v139, v139
    v_mfma_f32_32x32x16_bf16 v[188:203], v[28:31], v[248:251], 0
    v_cvt_pk_bf16_f32 v98, v136, v137
    v_cvt_pk_bf16_f32 v99, v138, v139
    ds_read_b128 v[36:39], v2 offset:0
    ds_read_b64 v[40:41], v3 offset:0
    v_mfma_f32_32x32x16_bf16 v[204:219], v[72:75], v[96:99], v[204:219]
    v_exp_f32 v172, v172
    v_exp_f32 v173, v173
    v_exp_f32 v174, v174
    v_exp_f32 v175, v175
    v_cvt_pk_bf16_f32 v100, v172, v173
    v_mfma_f32_32x32x16_bf16 v[156:171], v[44:47], v[248:251], 0
    v_exp_f32 v176, v176
    v_exp_f32 v177, v177
    v_exp_f32 v178, v178
    v_exp_f32 v179, v179
    v_cvt_pk_bf16_f32 v101, v174, v175
    v_mfma_f32_32x32x16_bf16 v[156:171], v[48:51], v[252:255], v[156:171]
    v_cvt_pk_bf16_f32 v102, v176, v177
    v_cvt_pk_bf16_f32 v103, v178, v179
    v_exp_f32 v180, v180
    v_exp_f32 v181, v181
    v_exp_f32 v182, v182
    v_exp_f32 v183, v183
    v_mfma_f32_32x32x16_bf16 v[220:235], v[68:71], v[100:103], v[220:235]
    v_exp_f32 v184, v184
    v_exp_f32 v185, v185
    v_cvt_pk_bf16_f32 v104, v180, v181
    v_cvt_pk_bf16_f32 v105, v182, v183
    v_exp_f32 v186, v186
    v_exp_f32 v187, v187
    v_mfma_f32_32x32x16_bf16 v[188:203], v[32:35], v[252:255], v[188:203]
    v_cvt_pk_bf16_f32 v106, v184, v185
    v_cvt_pk_bf16_f32 v107, v186, v187
    s_waitcnt lgkmcnt(0)
    s_nop 0
    v_mfma_f32_32x32x16_bf16 v[220:235], v[72:75], v[104:107], v[220:235]
    ds_read_b64_tr_b16 v[68:69], v4 offset:0
    ds_read_b64_tr_b16 v[70:71], v4 offset:128
    v_exp_f32 v108, v108
    v_exp_f32 v109, v109
    v_exp_f32 v110, v110
    v_exp_f32 v111, v111
    v_cvt_pk_bf16_f32 v92, v108, v109
    v_mfma_f32_32x32x16_bf16 v[124:139], v[44:47], v[16:19], 0
    ds_read_b64_tr_b16 v[72:73], v4 offset:256
    ds_read_b64_tr_b16 v[74:75], v4 offset:384
    v_exp_f32 v112, v112
    v_exp_f32 v113, v113
    v_exp_f32 v114, v114
    v_exp_f32 v115, v115
    v_cvt_pk_bf16_f32 v93, v110, v111
    v_mfma_f32_32x32x16_bf16 v[124:139], v[48:51], v[20:23], v[124:139]
    v_cvt_pk_bf16_f32 v94, v112, v113
    v_cvt_pk_bf16_f32 v95, v114, v115
    v_exp_f32 v116, v116
    v_exp_f32 v117, v117
    v_exp_f32 v118, v118
    v_exp_f32 v119, v119
    v_mfma_f32_32x32x16_bf16 v[204:219], v[60:63], v[92:95], v[204:219]
    v_exp_f32 v120, v120
    v_exp_f32 v121, v121
    v_cvt_pk_bf16_f32 v96, v116, v117
    v_cvt_pk_bf16_f32 v97, v118, v119
    v_exp_f32 v122, v122
    v_exp_f32 v123, v123
    v_mfma_f32_32x32x16_bf16 v[140:155], v[36:39], v[16:19], 0
    v_cvt_pk_bf16_f32 v98, v120, v121
    v_cvt_pk_bf16_f32 v99, v122, v123
    s_nop 1
    v_mfma_f32_32x32x16_bf16 v[204:219], v[64:67], v[96:99], v[204:219]
    v_exp_f32 v156, v156
    v_exp_f32 v157, v157
    v_exp_f32 v158, v158
    v_exp_f32 v159, v159
    v_cvt_pk_bf16_f32 v100, v156, v157
    v_mfma_f32_32x32x16_bf16 v[172:187], v[52:55], v[248:251], 0
    v_exp_f32 v160, v160
    v_exp_f32 v161, v161
    v_exp_f32 v162, v162
    v_exp_f32 v163, v163
    v_cvt_pk_bf16_f32 v101, v158, v159
    v_mfma_f32_32x32x16_bf16 v[172:187], v[56:59], v[252:255], v[172:187]
    v_cvt_pk_bf16_f32 v102, v160, v161
    v_cvt_pk_bf16_f32 v103, v162, v163
    v_exp_f32 v164, v164
    v_exp_f32 v165, v165
    v_exp_f32 v166, v166
    v_exp_f32 v167, v167
    v_mfma_f32_32x32x16_bf16 v[220:235], v[76:79], v[100:103], v[220:235]
    v_exp_f32 v168, v168
    v_exp_f32 v169, v169
    v_cvt_pk_bf16_f32 v104, v164, v165
    v_cvt_pk_bf16_f32 v105, v166, v167
    v_exp_f32 v170, v170
    v_exp_f32 v171, v171
    v_mfma_f32_32x32x16_bf16 v[140:155], v[40:43], v[20:23], v[140:155]
    v_cvt_pk_bf16_f32 v106, v168, v169
    v_cvt_pk_bf16_f32 v107, v170, v171
    s_waitcnt lgkmcnt(0)
    s_nop 0
    v_mfma_f32_32x32x16_bf16 v[220:235], v[80:83], v[104:107], v[220:235]
    v_cndmask_b32 v172, v188, v172, s[64:65]
    v_cndmask_b32 v173, v189, v173, s[66:67]
    v_cndmask_b32 v174, v190, v174, s[68:69]
    v_cndmask_b32 v175, v191, v175, s[70:71]
    v_cndmask_b32 v176, v192, v176, s[72:73]
    v_cndmask_b32 v177, v193, v177, s[74:75]
    v_cndmask_b32 v178, v194, v178, s[76:77]
    v_cndmask_b32 v179, v195, v179, s[78:79]
    v_cndmask_b32 v180, v196, v180, s[80:81]
    v_cndmask_b32 v181, v197, v181, s[82:83]
    v_cndmask_b32 v182, v198, v182, s[84:85]
    v_cndmask_b32 v183, v199, v183, s[86:87]
    v_cndmask_b32 v184, v200, v184, s[88:89]
    v_cndmask_b32 v185, v201, v185, s[90:91]
    v_cndmask_b32 v186, v202, v186, s[92:93]
    v_cndmask_b32 v187, v203, v187, s[94:95]
    v_exp_f32 v172, v172
    v_exp_f32 v173, v173
    v_exp_f32 v174, v174
    v_exp_f32 v175, v175
    v_exp_f32 v176, v176
    v_exp_f32 v177, v177
    v_exp_f32 v178, v178
    v_exp_f32 v179, v179
    v_cvt_pk_bf16_f32 v188, v172, v173
    v_cvt_pk_bf16_f32 v189, v174, v175
    v_cvt_pk_bf16_f32 v190, v176, v177
    v_cvt_pk_bf16_f32 v191, v178, v179
    v_and_b32 v100, v236, v188
    v_and_b32 v101, v237, v189
    v_and_b32 v102, v238, v190
    v_and_b32 v103, v239, v191
    v_xor_b32 v188, v100, v188
    v_xor_b32 v189, v101, v189
    v_xor_b32 v190, v102, v190
    v_xor_b32 v191, v103, v191
    v_mfma_f32_32x32x16_bf16 v[220:235], v[84:87], v[100:103], v[220:235]
    v_exp_f32 v180, v180
    v_exp_f32 v181, v181
    v_exp_f32 v182, v182
    v_exp_f32 v183, v183
    v_mfma_f32_32x32x16_bf16 v[220:235], v[60:63], v[188:191], v[220:235]
    v_exp_f32 v184, v184
    v_exp_f32 v185, v185
    v_exp_f32 v186, v186
    v_exp_f32 v187, v187
    v_cvt_pk_bf16_f32 v192, v180, v181
    v_cvt_pk_bf16_f32 v193, v182, v183
    v_cvt_pk_bf16_f32 v194, v184, v185
    v_cvt_pk_bf16_f32 v195, v186, v187
    v_and_b32 v104, v240, v192
    v_and_b32 v105, v241, v193
    v_and_b32 v106, v242, v194
    v_and_b32 v107, v243, v195
    v_xor_b32 v192, v104, v192
    v_xor_b32 v193, v105, v193
    v_xor_b32 v194, v106, v194
    v_xor_b32 v195, v107, v195
    v_mfma_f32_32x32x16_bf16 v[220:235], v[88:91], v[104:107], v[220:235]
    s_nop 0
    v_mfma_f32_32x32x16_bf16 v[220:235], v[64:67], v[192:195], v[220:235]
    v_cndmask_b32 v124, v140, v124, s[64:65]
    v_cndmask_b32 v125, v141, v125, s[66:67]
    v_cndmask_b32 v126, v142, v126, s[68:69]
    v_cndmask_b32 v127, v143, v127, s[70:71]
    v_cndmask_b32 v128, v144, v128, s[72:73]
    v_cndmask_b32 v129, v145, v129, s[74:75]
    v_cndmask_b32 v130, v146, v130, s[76:77]
    v_cndmask_b32 v131, v147, v131, s[78:79]
    v_cndmask_b32 v132, v148, v132, s[80:81]
    v_cndmask_b32 v133, v149, v133, s[82:83]
    v_cndmask_b32 v134, v150, v134, s[84:85]
    v_cndmask_b32 v135, v151, v135, s[86:87]
    v_cndmask_b32 v136, v152, v136, s[88:89]
    v_cndmask_b32 v137, v153, v137, s[90:91]
    v_cndmask_b32 v138, v154, v138, s[92:93]
    v_cndmask_b32 v139, v155, v139, s[94:95]
    v_exp_f32 v124, v124
    v_exp_f32 v125, v125
    v_exp_f32 v126, v126
    v_exp_f32 v127, v127
    v_exp_f32 v128, v128
    v_exp_f32 v129, v129
    v_exp_f32 v130, v130
    v_exp_f32 v131, v131
    v_cvt_pk_bf16_f32 v140, v124, v125
    v_cvt_pk_bf16_f32 v141, v126, v127
    v_cvt_pk_bf16_f32 v142, v128, v129
    v_cvt_pk_bf16_f32 v143, v130, v131
    v_and_b32 v92, v236, v140
    v_and_b32 v93, v237, v141
    v_and_b32 v94, v238, v142
    v_and_b32 v95, v239, v143
    v_xor_b32 v140, v92, v140
    v_xor_b32 v141, v93, v141
    v_xor_b32 v142, v94, v142
    v_xor_b32 v143, v95, v143
    v_mfma_f32_32x32x16_bf16 v[204:219], v[76:79], v[92:95], v[204:219]
    v_exp_f32 v132, v132
    v_exp_f32 v133, v133
    v_exp_f32 v134, v134
    v_exp_f32 v135, v135
    v_mfma_f32_32x32x16_bf16 v[204:219], v[68:71], v[140:143], v[204:219]
    v_exp_f32 v136, v136
    v_exp_f32 v137, v137
    v_exp_f32 v138, v138
    v_exp_f32 v139, v139
    v_cvt_pk_bf16_f32 v144, v132, v133
    v_cvt_pk_bf16_f32 v145, v134, v135
    v_cvt_pk_bf16_f32 v146, v136, v137
    v_cvt_pk_bf16_f32 v147, v138, v139
    v_and_b32 v96, v240, v144
    v_and_b32 v97, v241, v145
    v_and_b32 v98, v242, v146
    v_and_b32 v99, v243, v147
    v_xor_b32 v144, v96, v144
    v_xor_b32 v145, v97, v145
    v_xor_b32 v146, v98, v146
    v_xor_b32 v147, v99, v147
    v_mfma_f32_32x32x16_bf16 v[204:219], v[80:83], v[96:99], v[204:219]
    s_nop 0
    v_mfma_f32_32x32x16_bf16 v[204:219], v[72:75], v[144:147], v[204:219]
    s_mov_b32 s48, 8388608
    s_lshl_b32 s47, s44, 2
    s_add_u32 s47, s47, s46
    s_lshl_b32 s47, s47, 5
    s_add_u32 s47, s47, s45
    s_lshl_b32 s47, s47, 2
    s_add_u32 s53, s47, 14745600
    s_mov_b64 s[96:97], 0
    s_nop 3
L_aret_63:
    v_mov_b32 v24, v228
    v_mov_b32 v25, v228
    v_add_f32 v26, |v220|, |v221|
    v_add_f32 v27, |v222|, |v223|
    v_permlane32_swap_b32 v24, v25
    v_add_f32 v26, v26, |v224|
    v_add_f32 v27, v27, |v225|
    v_mov_b32 v8, v212
    v_add_f32 v26, v26, |v226|
    v_mov_b32 v9, v212
    v_add_f32 v27, v27, |v227|
    v_add_f32 v10, |v204|, |v205|
    v_add_f32 v26, v26, |v228|
    v_add_f32 v11, |v206|, |v207|
    v_add_f32 v27, v27, |v229|
    v_permlane32_swap_b32 v8, v9
    v_add_f32 v26, v26, |v230|
    v_add_f32 v10, v10, |v208|
    v_add_f32 v27, v27, |v231|
    v_add_f32 v11, v11, |v209|
    v_rcp_f32 v24, v25
    v_add_f32 v10, v10, |v210|
    v_add_f32 v26, v26, v27
    v_add_f32 v11, v11, |v211|
    v_add_f32 v10, v10, |v212|
    v_add_f32 v11, v11, |v213|
    v_add_f32 v10, v10, |v214|
    v_add_f32 v11, v11, |v215|
    v_rcp_f32 v8, v9
    v_add_f32 v10, v10, v11
    v_mov_b32 v11, 226492416
    v_mov_b32 v27, 2071986176
    v_cmp_nle_f32 s[54:55], v11, v9
    v_cmp_nge_f32 s[56:57], v27, v10
    v_cmp_nle_f32 s[58:59], v11, v25
    v_cmp_nge_f32 vcc, v27, v26
    v_mul_f32 v220, v24, v220
    v_mul_f32 v221, v24, v221
    v_mul_f32 v222, v24, v222
    v_mul_f32 v223, v24, v223
    v_mul_f32 v224, v24, v224
    v_mul_f32 v225, v24, v225
    v_mul_f32 v226, v24, v226
    v_mul_f32 v227, v24, v227
    v_mul_f32 v228, v24, v228
    v_mul_f32 v229, v24, v229
    v_mul_f32 v230, v24, v230
    v_mul_f32 v231, v24, v231
    s_or_b64 s[54:55], s[54:55], s[56:57]
    s_or_b64 s[58:59], s[58:59], vcc
    s_or_b64 vcc, s[54:55], s[58:59]
    s_andn2_b64 vcc, vcc, s[96:97]
    s_cbranch_vccnz L_afall_64
    v_cvt_pk_bf16_f32 v100, v220, v221
    v_cvt_pk_bf16_f32 v101, v222, v223
    v_cvt_pk_bf16_f32 v102, v224, v225
    v_cvt_pk_bf16_f32 v103, v226, v227
    v_cvt_pk_bf16_f32 v104, v228, v229
    v_cvt_pk_bf16_f32 v105, v230, v231
    v_mul_f32 v204, v8, v204
    v_mul_f32 v205, v8, v205
    v_mul_f32 v206, v8, v206
    v_mul_f32 v207, v8, v207
    v_permlane32_swap_b32 v100, v102
    v_permlane32_swap_b32 v101, v103
    v_mul_f32 v208, v8, v208
    v_mul_f32 v209, v8, v209
    v_mul_f32 v210, v8, v210
    v_mul_f32 v211, v8, v211
    v_mul_f32 v212, v8, v212
    v_mul_f32 v213, v8, v213
    v_mul_f32 v214, v8, v214
    v_mul_f32 v215, v8, v215
    v_cvt_pk_bf16_f32 v92, v204, v205
    v_cvt_pk_bf16_f32 v93, v206, v207
    v_cvt_pk_bf16_f32 v94, v208, v209
    v_cvt_pk_bf16_f32 v95, v210, v211
    v_cvt_pk_bf16_f32 v96, v212, v213
    v_cvt_pk_bf16_f32 v97, v214, v215
    v_permlane32_swap_b32 v92, v94
    v_permlane32_swap_b32 v93, v95
    s_cmp_eq_u32 s27, 1
    s_cbranch_scc0 L_og_65
    buffer_store_dwordx4 v[100:103], v7, s[36:39], s48 offen offset:512
    buffer_store_dwordx4 v[92:95], v7, s[36:39], s48 offen offset:0
    s_mov_b32 exec_hi, 0
    buffer_store_dwordx2 v[104:105], v244, s[36:39], s48 offen offset:512
    buffer_store_dwordx2 v[96:97], v244, s[36:39], s48 offen offset:0
    s_mov_b32 exec_hi, -1
    v_lshrrev_b32 v16, 4, v1
    v_mul_u32_u24 v16, 1280, v16
    v_and_b32 v17, 15, v1
    v_lshl_add_u32 v16, v17, 4, v16
    v_add_u32 v2, 57856, v16
    v_add_u32 v3, 119296, v16
    s_mov_b64 exec, 1
    v_mov_b32 v8, s53
    v_mov_b32 v9, s26
    s_waitcnt vmcnt(0)
    buffer_store_dword v9, v8, s[36:39], 0 offen
    s_mov_b64 exec, -1
L_on_66:
    s_lshl_b32 s47, s46, 2
    v_add_u32 v9, s47, v13
    s_mov_b64 exec, 1
    v_mov_b32 v8, 1
    ds_write_b32 v9, v8 offset:32320
    s_mov_b64 exec, -1
    s_lshl_b32 s49, s44, 2
    s_lshr_b32 s48, s45, 3
    s_add_u32 s49, s49, s48
    v_and_b32 v12, 31, v1
    s_lshl_b32 s47, s49, 7
    v_lshl_add_u32 v12, v12, 2, s47
    s_lshl_b32 s49, s49, 2
    s_add_u32 s49, s49, s46
    s_lshl_b32 s47, s49, 8
    v_and_b32 v9, 15, v1
    v_lshl_add_u32 v11, v9, 4, s47
    v_lshrrev_b32 v10, 4, v1
    v_lshl_add_u32 v24, v10, 15, v11
    s_mov_b32 s47, 14745600
    buffer_load_dword v23, v12, s[36:39], s47 offen sc1
    s_mov_b32 s48, 0
L_ww_69:
    ds_read_b128 v[208:211], v13 offset:32336
    s_waitcnt lgkmcnt(0)
    v_and_b32 v208, v208, v209
    v_and_b32 v210, v210, v211
    v_and_b32 v208, v208, v210
    v_cmp_ne_u32 vcc, 1, v208
    s_cbranch_vccz L_wwd_70
    s_add_u32 s48, s48, 1
    s_cmp_lt_u32 s48, 0x400000
    s_cbranch_scc1 L_ww_69
L_wwd_70:
    ds_read_b128 v[28:31], v2 offset:0
    ds_read_b128 v[32:35], v2 offset:256
    ds_read_b128 v[36:39], v2 offset:512
    ds_read_b128 v[40:43], v2 offset:768
    ds_read_b128 v[44:47], v2 offset:1024
    ds_read_b128 v[48:51], v2 offset:5120
    ds_read_b128 v[52:55], v2 offset:5376
    ds_read_b128 v[56:59], v2 offset:5632
    ds_read_b128 v[60:63], v2 offset:5888
    ds_read_b128 v[64:67], v2 offset:6144
    ds_read_b128 v[68:71], v2 offset:10240
    ds_read_b128 v[72:75], v2 offset:10496
    ds_read_b128 v[76:79], v2 offset:10752
    ds_read_b128 v[80:83], v2 offset:11008
    ds_read_b128 v[84:87], v2 offset:11264
    ds_read_b128 v[88:91], v2 offset:15360
    ds_read_b128 v[92:95], v2 offset:15616
    ds_read_b128 v[96:99], v2 offset:15872
    ds_read_b128 v[100:103], v2 offset:16128
    ds_read_b128 v[104:107], v2 offset:16384
    ds_read_b128 v[108:111], v2 offset:20480
    ds_read_b128 v[112:115], v2 offset:20736
    ds_read_b128 v[116:119], v2 offset:20992
    ds_read_b128 v[120:123], v2 offset:21248
    ds_read_b128 v[124:127], v2 offset:21504
    ds_read_b128 v[128:131], v2 offset:25600
    ds_read_b128 v[132:135], v2 offset:25856
    ds_read_b128 v[136:139], v2 offset:26112
    ds_read_b128 v[140:143], v2 offset:26368
    ds_read_b128 v[144:147], v2 offset:26624
    s_waitcnt vmcnt(0)
    v_cmp_ne_u32 vcc, s26, v23
    s_cbranch_vccz L_fok_67
    ds_read_b128 v[148:151], v2 offset:30720
    ds_read_b128 v[152:155], v2 offset:30976
    ds_read_b128 v[156:159], v2 offset:31232
    ds_read_b128 v[160:163], v2 offset:31488
    ds_read_b128 v[164:167], v2 offset:31744
    ds_read_b128 v[168:171], v2 offset:35840
    ds_read_b128 v[172:175], v2 offset:36096
    ds_read_b128 v[176:179], v2 offset:36352
    ds_read_b128 v[180:183], v2 offset:36608
    ds_read_b128 v[184:187], v2 offset:36864
    ds_read_b128 v[188:191], v2 offset:40960
    ds_read_b128 v[192:195], v2 offset:41216
    ds_read_b128 v[196:199], v2 offset:41472
    ds_read_b128 v[200:203], v2 offset:41728
    ds_read_b128 v[204:207], v2 offset:41984
    s_mov_b32 s50, 0
    s_mov_b32 s51, 14745600
L_poll_71:
    buffer_load_dword v23, v12, s[36:39], s51 offen sc1
    s_waitcnt vmcnt(0)
    v_xor_b32 v23, s26, v23
    v_cmp_ne_u32 vcc, 0, v23
    s_cbranch_vccz L_polld_72
    s_add_u32 s50, s50, 1
    s_cmp_lt_u32 s50, 0x100000
    s_cbranch_scc1 L_poll_71
L_polld_72:
    s_mov_b32 s52, 8388608
    buffer_load_dwordx4 v[208:211], v24, s[36:39], s52 offen sc1
    s_mov_b32 s52, 8519680
    buffer_load_dwordx4 v[212:215], v24, s[36:39], s52 offen sc1
    s_mov_b32 s52, 8650752
    buffer_load_dwordx4 v[216:219], v24, s[36:39], s52 offen sc1
    s_mov_b32 s52, 8781824
    buffer_load_dwordx4 v[220:223], v24, s[36:39], s52 offen sc1
    s_mov_b32 s52, 8912896
    buffer_load_dwordx4 v[224:227], v24, s[36:39], s52 offen sc1
    s_mov_b32 s52, 9043968
    buffer_load_dwordx4 v[228:231], v24, s[36:39], s52 offen sc1
    s_mov_b32 s52, 9175040
    buffer_load_dwordx4 v[232:235], v24, s[36:39], s52 offen sc1
    s_branch L_fgo_68
L_fok_67:
    s_mov_b32 s52, 8388608
    buffer_load_dwordx4 v[208:211], v24, s[36:39], s52 offen sc1
    s_mov_b32 s52, 8519680
    buffer_load_dwordx4 v[212:215], v24, s[36:39], s52 offen sc1
    s_mov_b32 s52, 8650752
    buffer_load_dwordx4 v[216:219], v24, s[36:39], s52 offen sc1
    s_mov_b32 s52, 8781824
    buffer_load_dwordx4 v[220:223], v24, s[36:39], s52 offen sc1
    s_mov_b32 s52, 8912896
    buffer_load_dwordx4 v[224:227], v24, s[36:39], s52 offen sc1
    s_mov_b32 s52, 9043968
    buffer_load_dwordx4 v[228:231], v24, s[36:39], s52 offen sc1
    s_mov_b32 s52, 9175040
    buffer_load_dwordx4 v[232:235], v24, s[36:39], s52 offen sc1
    ds_read_b128 v[148:151], v2 offset:30720
    ds_read_b128 v[152:155], v2 offset:30976
    ds_read_b128 v[156:159], v2 offset:31232
    ds_read_b128 v[160:163], v2 offset:31488
    ds_read_b128 v[164:167], v2 offset:31744
    ds_read_b128 v[168:171], v2 offset:35840
    ds_read_b128 v[172:175], v2 offset:36096
    ds_read_b128 v[176:179], v2 offset:36352
    ds_read_b128 v[180:183], v2 offset:36608
    ds_read_b128 v[184:187], v2 offset:36864
    ds_read_b128 v[188:191], v2 offset:40960
    ds_read_b128 v[192:195], v2 offset:41216
    ds_read_b128 v[196:199], v2 offset:41472
    ds_read_b128 v[200:203], v2 offset:41728
    ds_read_b128 v[204:207], v2 offset:41984
L_fgo_68:
    s_mov_b32 s48, 0
L_ww_73:
    ds_read_b128 v[8:11], v13 offset:32368
    s_waitcnt lgkmcnt(0)
    v_and_b32 v8, v8, v9
    v_and_b32 v10, v10, v11
    v_and_b32 v8, v8, v10
    v_cmp_ne_u32 vcc, 1, v8
    s_cbranch_vccz L_wwd_74
    s_add_u32 s48, s48, 1
    s_cmp_lt_u32 s48, 0x400000
    s_cbranch_scc1 L_ww_73
L_wwd_74:
    s_mov_b32 s48, 0
L_ww_75:
    ds_read_b128 v[8:11], v13 offset:32320
    s_waitcnt lgkmcnt(0)
    v_and_b32 v8, v8, v9
    v_and_b32 v10, v10, v11
    v_and_b32 v8, v8, v10
    v_cmp_ne_u32 vcc, 1, v8
    s_cbranch_vccz L_wwd_76
    s_add_u32 s48, s48, 1
    s_cmp_lt_u32 s48, 0x400000
    s_cbranch_scc1 L_ww_75
L_wwd_76:
    v_mov_b32 v26, 1
    s_lshl_b32 s47, s46, 2
    v_add_u32 v27, s47, v13
    v_and_b32 v9, 15, v1
    v_lshrrev_b32 v10, 4, v1
    s_mul_i32 s47, s46, 3072
    s_add_u32 s47, s47, 32768
    v_mul_u32_u24 v9, 176, v9
    s_waitcnt vmcnt(6)
.p2align 3
    v_mfma_f32_16x16x32_bf16 v[236:239], v[28:31], v[208:211], 0
    ds_read_b128 v[28:31], v2 offset:46080
    v_mfma_f32_16x16x32_bf16 v[240:243], v[32:35], v[208:211], 0
    ds_read_b128 v[32:35], v2 offset:46336
    v_mfma_f32_16x16x32_bf16 v[244:247], v[36:39], v[208:211], 0
    ds_read_b128 v[36:39], v2 offset:46592
    v_mfma_f32_16x16x32_bf16 v[248:251], v[40:43], v[208:211], 0
    ds_read_b128 v[40:43], v2 offset:46848
    v_mfma_f32_16x16x32_bf16 v[252:255], v[44:47], v[208:211], 0
    s_mov_b32 s52, 9306112
    buffer_load_dwordx4 v[208:211], v24, s[36:39], s52 offen sc1
    ds_write_b32 v27, v26 offset:32400
    s_waitcnt vmcnt(6)
.p2align 3
    v_mfma_f32_16x16x32_bf16 v[236:239], v[48:51], v[212:215], v[236:239]
    ds_read_b128 v[44:47], v2 offset:47104
    v_mfma_f32_16x16x32_bf16 v[240:243], v[52:55], v[212:215], v[240:243]
    ds_read_b128 v[48:51], v2 offset:51200
    v_mfma_f32_16x16x32_bf16 v[244:247], v[56:59], v[212:215], v[244:247]
    ds_read_b128 v[52:55], v2 offset:51456
    v_mfma_f32_16x16x32_bf16 v[248:251], v[60:63], v[212:215], v[248:251]
    ds_read_b128 v[56:59], v2 offset:51712
    v_mfma_f32_16x16x32_bf16 v[252:255], v[64:67], v[212:215], v[252:255]
    s_mov_b32 s52, 9437184
    buffer_load_dwordx4 v[212:215], v24, s[36:39], s52 offen sc1
    s_waitcnt vmcnt(6)
.p2align 3
    v_mfma_f32_16x16x32_bf16 v[236:239], v[68:71], v[216:219], v[236:239]
    ds_read_b128 v[60:63], v2 offset:51968
    v_mfma_f32_16x16x32_bf16 v[240:243], v[72:75], v[216:219], v[240:243]
    ds_read_b128 v[64:67], v2 offset:52224
    v_mfma_f32_16x16x32_bf16 v[244:247], v[76:79], v[216:219], v[244:247]
    ds_read_b128 v[68:71], v2 offset:56320
    v_mfma_f32_16x16x32_bf16 v[248:251], v[80:83], v[216:219], v[248:251]
    ds_read_b128 v[72:75], v2 offset:56576
    v_mfma_f32_16x16x32_bf16 v[252:255], v[84:87], v[216:219], v[252:255]
    s_mov_b32 s52, 9568256
    buffer_load_dwordx4 v[216:219], v24, s[36:39], s52 offen sc1
    s_waitcnt vmcnt(6)
.p2align 3
    v_mfma_f32_16x16x32_bf16 v[236:239], v[88:91], v[220:223], v[236:239]
    ds_read_b128 v[76:79], v2 offset:56832
    v_mfma_f32_16x16x32_bf16 v[240:243], v[92:95], v[220:223], v[240:243]
    ds_read_b128 v[80:83], v2 offset:57088
    v_mfma_f32_16x16x32_bf16 v[244:247], v[96:99], v[220:223], v[244:247]
    ds_read_b128 v[84:87], v2 offset:57344
    v_mfma_f32_16x16x32_bf16 v[248:251], v[100:103], v[220:223], v[248:251]
    ds_read_b128 v[88:91], v3 offset:0
    v_mfma_f32_16x16x32_bf16 v[252:255], v[104:107], v[220:223], v[252:255]
    s_mov_b32 s52, 9699328
    buffer_load_dwordx4 v[220:223], v24, s[36:39], s52 offen sc1
    s_waitcnt vmcnt(6)
.p2align 3
    v_mfma_f32_16x16x32_bf16 v[236:239], v[108:111], v[224:227], v[236:239]
    ds_read_b128 v[92:95], v3 offset:256
    v_mfma_f32_16x16x32_bf16 v[240:243], v[112:115], v[224:227], v[240:243]
    ds_read_b128 v[96:99], v3 offset:512
    v_mfma_f32_16x16x32_bf16 v[244:247], v[116:119], v[224:227], v[244:247]
    ds_read_b128 v[100:103], v3 offset:768
    v_mfma_f32_16x16x32_bf16 v[248:251], v[120:123], v[224:227], v[248:251]
    ds_read_b128 v[104:107], v3 offset:1024
    v_mfma_f32_16x16x32_bf16 v[252:255], v[124:127], v[224:227], v[252:255]
    s_mov_b32 s52, 9830400
    buffer_load_dwordx4 v[224:227], v24, s[36:39], s52 offen sc1
    s_waitcnt vmcnt(6)
.p2align 3
    v_mfma_f32_16x16x32_bf16 v[236:239], v[128:131], v[228:231], v[236:239]
    ds_read_b128 v[108:111], v3 offset:5120
    v_mfma_f32_16x16x32_bf16 v[240:243], v[132:135], v[228:231], v[240:243]
    ds_read_b128 v[112:115], v3 offset:5376
    v_mfma_f32_16x16x32_bf16 v[244:247], v[136:139], v[228:231], v[244:247]
    ds_read_b128 v[116:119], v3 offset:5632
    v_mfma_f32_16x16x32_bf16 v[248:251], v[140:143], v[228:231], v[248:251]
    ds_read_b128 v[120:123], v3 offset:5888
    v_mfma_f32_16x16x32_bf16 v[252:255], v[144:147], v[228:231], v[252:255]
    s_mov_b32 s52, 9961472
    buffer_load_dwordx4 v[228:231], v24, s[36:39], s52 offen sc1
    s_waitcnt vmcnt(6)
.p2align 3
    v_mfma_f32_16x16x32_bf16 v[236:239], v[148:151], v[232:235], v[236:239]
    ds_read_b128 v[124:127], v3 offset:6144
    v_lshl_add_u32 v9, v10, 3, v9
    v_mfma_f32_16x16x32_bf16 v[240:243], v[152:155], v[232:235], v[240:243]
    ds_read_b128 v[128:131], v3 offset:10240
    v_add_u32 v22, s47, v9
    v_mfma_f32_16x16x32_bf16 v[244:247], v[156:159], v[232:235], v[244:247]
    ds_read_b128 v[132:135], v3 offset:10496
    s_mul_i32 s48, s49, 40960
    v_mfma_f32_16x16x32_bf16 v[248:251], v[160:163], v[232:235], v[248:251]
    ds_read_b128 v[136:139], v3 offset:10752
    s_and_b32 s50, s45, 7
    v_mfma_f32_16x16x32_bf16 v[252:255], v[164:167], v[232:235], v[252:255]
    s_mul_i32 s50, s50, 160
    s_mov_b32 s52, 10092544
    buffer_load_dwordx4 v[232:235], v24, s[36:39], s52 offen sc1
    s_waitcnt vmcnt(6)
.p2align 3
    v_mfma_f32_16x16x32_bf16 v[236:239], v[168:171], v[208:211], v[236:239]
    ds_read_b128 v[140:143], v3 offset:11008
    s_add_u32 s50, s48, s50
    v_mfma_f32_16x16x32_bf16 v[240:243], v[172:175], v[208:211], v[240:243]
    ds_read_b128 v[144:147], v3 offset:11264
    s_mov_b32 s40, s20
    v_mfma_f32_16x16x32_bf16 v[244:247], v[176:179], v[208:211], v[244:247]
    ds_read_b128 v[148:151], v3 offset:15360
    s_mov_b32 s41, s21
    v_mfma_f32_16x16x32_bf16 v[248:251], v[180:183], v[208:211], v[248:251]
    ds_read_b128 v[152:155], v3 offset:15616
    s_mov_b32 s42, 5242880
    v_mfma_f32_16x16x32_bf16 v[252:255], v[184:187], v[208:211], v[252:255]
    s_mov_b32 s43, 0x20000
    s_mov_b32 s52, 10223616
    buffer_load_dwordx4 v[208:211], v24, s[36:39], s52 offen sc1
    s_waitcnt vmcnt(6)
.p2align 3
    v_mfma_f32_16x16x32_bf16 v[236:239], v[188:191], v[212:215], v[236:239]
    ds_read_b128 v[156:159], v3 offset:15872
    v_add_u32 v9, 0, v1
    v_mfma_f32_16x16x32_bf16 v[240:243], v[192:195], v[212:215], v[240:243]
    ds_read_b128 v[160:163], v3 offset:16128
    v_mul_u32_u24 v10, 6554, v9
    v_mfma_f32_16x16x32_bf16 v[244:247], v[196:199], v[212:215], v[244:247]
    ds_read_b128 v[164:167], v3 offset:16384
    v_lshrrev_b32 v10, 16, v10
    v_mfma_f32_16x16x32_bf16 v[248:251], v[200:203], v[212:215], v[248:251]
    ds_read_b128 v[168:171], v3 offset:20480
    v_mul_u32_u24 v11, 10, v10
    v_mfma_f32_16x16x32_bf16 v[252:255], v[204:207], v[212:215], v[252:255]
    v_sub_u32 v11, v9, v11
    s_mov_b32 s52, 10354688
    buffer_load_dwordx4 v[212:215], v24, s[36:39], s52 offen sc1
    s_waitcnt vmcnt(6) lgkmcnt(15)
.p2align 3
    v_mfma_f32_16x16x32_bf16 v[236:239], v[28:31], v[216:219], v[236:239]
    ds_read_b128 v[172:175], v3 offset:20736
    v_mul_u32_u24 v16, 176, v10
    v_mfma_f32_16x16x32_bf16 v[240:243], v[32:35], v[216:219], v[240:243]
    ds_read_b128 v[176:179], v3 offset:20992
    v_lshl_add_u32 v16, v11, 4, v16
    v_mfma_f32_16x16x32_bf16 v[244:247], v[36:39], v[216:219], v[244:247]
    ds_read_b128 v[180:183], v3 offset:21248
    v_add_u32 v16, s47, v16
    v_mfma_f32_16x16x32_bf16 v[248:251], v[40:43], v[216:219], v[248:251]
    ds_read_b128 v[184:187], v3 offset:21504
    v_mul_u32_u24 v10, 2560, v10
    v_mfma_f32_16x16x32_bf16 v[252:255], v[44:47], v[216:219], v[252:255]
    v_lshl_add_u32 v10, v11, 4, v10
    s_mov_b32 s52, 10485760
    buffer_load_dwordx4 v[216:219], v24, s[36:39], s52 offen sc1
    ds_write_b32 v27, v26 offset:32384
    s_waitcnt vmcnt(6) lgkmcnt(15)
.p2align 3
    v_mfma_f32_16x16x32_bf16 v[236:239], v[48:51], v[220:223], v[236:239]
    ds_read_b128 v[188:191], v3 offset:25600
    v_add_u32 v19, s50, v10
    v_mfma_f32_16x16x32_bf16 v[240:243], v[52:55], v[220:223], v[240:243]
    ds_read_b128 v[192:195], v3 offset:25856
    v_add_u32 v9, 64, v1
    v_mfma_f32_16x16x32_bf16 v[244:247], v[56:59], v[220:223], v[244:247]
    ds_read_b128 v[196:199], v3 offset:26112
    v_mul_u32_u24 v10, 6554, v9
    v_mfma_f32_16x16x32_bf16 v[248:251], v[60:63], v[220:223], v[248:251]
    ds_read_b128 v[200:203], v3 offset:26368
    v_lshrrev_b32 v10, 16, v10
    v_mfma_f32_16x16x32_bf16 v[252:255], v[64:67], v[220:223], v[252:255]
    v_mul_u32_u24 v11, 10, v10
    s_mov_b32 s52, 10616832
    buffer_load_dwordx4 v[220:223], v24, s[36:39], s52 offen sc1
    s_waitcnt vmcnt(6) lgkmcnt(15)
.p2align 3
    v_mfma_f32_16x16x32_bf16 v[236:239], v[68:71], v[224:227], v[236:239]
    ds_read_b128 v[204:207], v3 offset:26624
    v_sub_u32 v11, v9, v11
    v_mfma_f32_16x16x32_bf16 v[240:243], v[72:75], v[224:227], v[240:243]
    ds_read_b128 v[28:31], v3 offset:30720
    v_mul_u32_u24 v17, 176, v10
    v_mfma_f32_16x16x32_bf16 v[244:247], v[76:79], v[224:227], v[244:247]
    ds_read_b128 v[32:35], v3 offset:30976
    v_lshl_add_u32 v17, v11, 4, v17
    v_mfma_f32_16x16x32_bf16 v[248:251], v[80:83], v[224:227], v[248:251]
    ds_read_b128 v[36:39], v3 offset:31232
    v_add_u32 v17, s47, v17
    v_mfma_f32_16x16x32_bf16 v[252:255], v[84:87], v[224:227], v[252:255]
    v_mul_u32_u24 v10, 2560, v10
    s_mov_b32 s52, 10747904
    buffer_load_dwordx4 v[224:227], v24, s[36:39], s52 offen sc1
    s_waitcnt vmcnt(6) lgkmcnt(15)
.p2align 3
    v_mfma_f32_16x16x32_bf16 v[236:239], v[88:91], v[228:231], v[236:239]
    ds_read_b128 v[40:43], v3 offset:31488
    v_lshl_add_u32 v10, v11, 4, v10
    v_mfma_f32_16x16x32_bf16 v[240:243], v[92:95], v[228:231], v[240:243]
    ds_read_b128 v[44:47], v3 offset:31744
    v_add_u32 v20, s50, v10
    v_mfma_f32_16x16x32_bf16 v[244:247], v[96:99], v[228:231], v[244:247]
    ds_read_b128 v[48:51], v3 offset:35840
    v_add_u32 v9, 128, v1
    v_mfma_f32_16x16x32_bf16 v[248:251], v[100:103], v[228:231], v[248:251]
    ds_read_b128 v[52:55], v3 offset:36096
    v_mul_u32_u24 v10, 6554, v9
    v_mfma_f32_16x16x32_bf16 v[252:255], v[104:107], v[228:231], v[252:255]
    v_lshrrev_b32 v10, 16, v10
    s_mov_b32 s52, 10878976
    buffer_load_dwordx4 v[228:231], v24, s[36:39], s52 offen sc1
    s_waitcnt vmcnt(6) lgkmcnt(15)
.p2align 3
    v_mfma_f32_16x16x32_bf16 v[236:239], v[108:111], v[232:235], v[236:239]
    ds_read_b128 v[56:59], v3 offset:36352
    v_mul_u32_u24 v11, 10, v10
    v_mfma_f32_16x16x32_bf16 v[240:243], v[112:115], v[232:235], v[240:243]
    ds_read_b128 v[60:63], v3 offset:36608
    v_sub_u32 v11, v9, v11
    v_mfma_f32_16x16x32_bf16 v[244:247], v[116:119], v[232:235], v[244:247]
    ds_read_b128 v[64:67], v3 offset:36864
    v_mul_u32_u24 v18, 176, v10
    v_mfma_f32_16x16x32_bf16 v[248:251], v[120:123], v[232:235], v[248:251]
    v_lshl_add_u32 v18, v11, 4, v18
    v_mfma_f32_16x16x32_bf16 v[252:255], v[124:127], v[232:235], v[252:255]
    v_add_u32 v18, s47, v18
    s_waitcnt vmcnt(5) lgkmcnt(15)
.p2align 3
    v_mfma_f32_16x16x32_bf16 v[236:239], v[128:131], v[208:211], v[236:239]
    v_mul_u32_u24 v10, 2560, v10
    v_mfma_f32_16x16x32_bf16 v[240:243], v[132:135], v[208:211], v[240:243]
    v_lshl_add_u32 v10, v11, 4, v10
    v_mfma_f32_16x16x32_bf16 v[244:247], v[136:139], v[208:211], v[244:247]
    v_add_u32 v21, s50, v10
    v_mfma_f32_16x16x32_bf16 v[248:251], v[140:143], v[208:211], v[248:251]
    v_mfma_f32_16x16x32_bf16 v[252:255], v[144:147], v[208:211], v[252:255]
    s_waitcnt vmcnt(4) lgkmcnt(15)
.p2align 3
    v_mfma_f32_16x16x32_bf16 v[236:239], v[148:151], v[212:215], v[236:239]
    v_mfma_f32_16x16x32_bf16 v[240:243], v[152:155], v[212:215], v[240:243]
    v_mfma_f32_16x16x32_bf16 v[244:247], v[156:159], v[212:215], v[244:247]
    v_mfma_f32_16x16x32_bf16 v[248:251], v[160:163], v[212:215], v[248:251]
    v_mfma_f32_16x16x32_bf16 v[252:255], v[164:167], v[212:215], v[252:255]
    s_waitcnt vmcnt(3) lgkmcnt(15)
.p2align 3
    v_mfma_f32_16x16x32_bf16 v[236:239], v[168:171], v[216:219], v[236:239]
    v_mfma_f32_16x16x32_bf16 v[240:243], v[172:175], v[216:219], v[240:243]
    v_mfma_f32_16x16x32_bf16 v[244:247], v[176:179], v[216:219], v[244:247]
    v_mfma_f32_16x16x32_bf16 v[248:251], v[180:183], v[216:219], v[248:251]
    v_mfma_f32_16x16x32_bf16 v[252:255], v[184:187], v[216:219], v[252:255]
    s_waitcnt vmcnt(2) lgkmcnt(10)
.p2align 3
    v_mfma_f32_16x16x32_bf16 v[236:239], v[188:191], v[220:223], v[236:239]
    v_mfma_f32_16x16x32_bf16 v[240:243], v[192:195], v[220:223], v[240:243]
    v_mfma_f32_16x16x32_bf16 v[244:247], v[196:199], v[220:223], v[244:247]
    v_mfma_f32_16x16x32_bf16 v[248:251], v[200:203], v[220:223], v[248:251]
    v_mfma_f32_16x16x32_bf16 v[252:255], v[204:207], v[220:223], v[252:255]
    s_waitcnt vmcnt(1) lgkmcnt(5)
.p2align 3
    v_mfma_f32_16x16x32_bf16 v[236:239], v[28:31], v[224:227], v[236:239]
    v_mfma_f32_16x16x32_bf16 v[240:243], v[32:35], v[224:227], v[240:243]
    v_mfma_f32_16x16x32_bf16 v[244:247], v[36:39], v[224:227], v[244:247]
    v_mfma_f32_16x16x32_bf16 v[248:251], v[40:43], v[224:227], v[248:251]
    v_mfma_f32_16x16x32_bf16 v[252:255], v[44:47], v[224:227], v[252:255]
    s_waitcnt vmcnt(0) lgkmcnt(0)
.p2align 3
    v_mfma_f32_16x16x32_bf16 v[236:239], v[48:51], v[228:231], v[236:239]
    v_mfma_f32_16x16x32_bf16 v[240:243], v[52:55], v[228:231], v[240:243]
    v_mfma_f32_16x16x32_bf16 v[244:247], v[56:59], v[228:231], v[244:247]
    v_mfma_f32_16x16x32_bf16 v[248:251], v[60:63], v[228:231], v[248:251]
    v_mfma_f32_16x16x32_bf16 v[252:255], v[64:67], v[228:231], v[252:255]
    s_nop 3
    v_cvt_pk_bf16_f32 v28, v236, v237
    v_cvt_pk_bf16_f32 v29, v238, v239
    ds_write_b64 v22, v[28:29] offset:0
    v_cvt_pk_bf16_f32 v30, v240, v241
    v_cvt_pk_bf16_f32 v31, v242, v243
    ds_write_b64 v22, v[30:31] offset:32
    v_cvt_pk_bf16_f32 v32, v244, v245
    v_cvt_pk_bf16_f32 v33, v246, v247
    ds_write_b64 v22, v[32:33] offset:64
    v_cvt_pk_bf16_f32 v34, v248, v249
    v_cvt_pk_bf16_f32 v35, v250, v251
    ds_write_b64 v22, v[34:35] offset:96
    v_cvt_pk_bf16_f32 v36, v252, v253
    v_cvt_pk_bf16_f32 v37, v254, v255
    ds_write_b64 v22, v[36:37] offset:128
    s_waitcnt lgkmcnt(0)
    ds_read_b128 v[40:43], v16
    ds_read_b128 v[44:47], v17
    ds_read_b128 v[48:51], v18
    s_waitcnt lgkmcnt(2)
    buffer_store_dwordx4 v[40:43], v19, s[40:43], 0 offen
    s_waitcnt lgkmcnt(1)
    buffer_store_dwordx4 v[44:47], v20, s[40:43], 0 offen
    s_waitcnt lgkmcnt(0)
    s_mov_b32 exec_hi, 0
    buffer_store_dwordx4 v[48:51], v21, s[40:43], 0 offen
L_fin_7:
    s_endpgm
L_cold_8:
L_og_65:
    buffer_store_dwordx4 v[100:103], v7, s[36:39], s48 offen offset:512 sc1
    buffer_store_dwordx4 v[92:95], v7, s[36:39], s48 offen offset:0 sc1
    s_mov_b32 exec_hi, 0
    buffer_store_dwordx2 v[104:105], v244, s[36:39], s48 offen offset:512 sc1
    buffer_store_dwordx2 v[96:97], v244, s[36:39], s48 offen offset:0 sc1
    s_mov_b32 exec_hi, -1
    v_lshrrev_b32 v16, 4, v1
    v_mul_u32_u24 v16, 1280, v16
    v_and_b32 v17, 15, v1
    v_lshl_add_u32 v16, v17, 4, v16
    v_add_u32 v2, 57856, v16
    v_add_u32 v3, 119296, v16
    s_mov_b64 exec, 1
    v_mov_b32 v8, s53
    v_mov_b32 v9, s26
    s_waitcnt vmcnt(0)
    buffer_store_dword v9, v8, s[36:39], 0 offen sc1
    s_mov_b64 exec, -1
    s_branch L_on_66
L_afall_64:
    s_mov_b64 s[96:97], -1
    s_mov_b64 s[62:63], s[58:59]
    s_cmp_eq_u64 s[54:55], 0
    s_cbranch_scc1 L_fbb_77
    v_mov_b32 v22, 0
    v_mov_b32 v128, 0xff800000
    s_mov_b32 s58, 0
    s_sub_u32 s59, 8, s100
    s_cmp_eq_u32 s44, 0
    s_cselect_b32 s59, s59, 0
    v_mov_b32 v204, 0
    v_mov_b32 v205, 0
    v_mov_b32 v206, 0
    v_mov_b32 v207, 0
    v_mov_b32 v208, 0
    v_mov_b32 v209, 0
    v_mov_b32 v210, 0
    v_mov_b32 v211, 0
    v_mov_b32 v212, 0
    v_mov_b32 v213, 0
    v_mov_b32 v214, 0
    v_mov_b32 v215, 0
    v_mov_b32 v216, 0
    v_mov_b32 v217, 0
    v_mov_b32 v218, 0
    v_mov_b32 v219, 0
L_fp_79:
    s_mov_b32 s57, s59
L_fb_80:
    s_lshl_b32 s47, s57, 9
    v_add_u32 v124, s47, v2
    v_add_u32 v125, s47, v3
    v_add_u32 v126, s47, v4
    ds_read_b128 v[28:31], v124 offset:0
    ds_read_b64 v[32:33], v125 offset:0
    ds_read_b64_tr_b16 v[60:61], v126 offset:0
    ds_read_b64_tr_b16 v[62:63], v126 offset:128
    ds_read_b64_tr_b16 v[64:65], v126 offset:256
    ds_read_b64_tr_b16 v[66:67], v126 offset:384
    s_sub_u32 s47, 8, s57
    s_lshl_b32 s47, s47, 5
    v_and_b32 v8, 31, v1
    v_lshrrev_b32 v9, 5, v1
    v_lshlrev_b32 v9, 2, v9
    v_sub_u32 v8, v8, v9
    v_add_u32 v127, s47, v8
    v_mov_b32 v9, 0xff800000
    s_waitcnt lgkmcnt(0)
    v_mfma_f32_32x32x16_bf16 v[108:123], v[28:31], v[16:19], 0
    v_mfma_f32_32x32x16_bf16 v[108:123], v[32:35], v[20:23], v[108:123]
    s_nop 7
    s_nop 7
    v_subrev_u32 v8, 0, v127
    v_cmp_gt_u32 vcc, 0x100, v8
    s_nop 1
    v_cndmask_b32 v108, v9, v108, vcc
    v_subrev_u32 v8, 1, v127
    v_cmp_gt_u32 vcc, 0x100, v8
    s_nop 1
    v_cndmask_b32 v109, v9, v109, vcc
    v_subrev_u32 v8, 2, v127
    v_cmp_gt_u32 vcc, 0x100, v8
    s_nop 1
    v_cndmask_b32 v110, v9, v110, vcc
    v_subrev_u32 v8, 3, v127
    v_cmp_gt_u32 vcc, 0x100, v8
    s_nop 1
    v_cndmask_b32 v111, v9, v111, vcc
    v_subrev_u32 v8, 8, v127
    v_cmp_gt_u32 vcc, 0x100, v8
    s_nop 1
    v_cndmask_b32 v112, v9, v112, vcc
    v_subrev_u32 v8, 9, v127
    v_cmp_gt_u32 vcc, 0x100, v8
    s_nop 1
    v_cndmask_b32 v113, v9, v113, vcc
    v_subrev_u32 v8, 10, v127
    v_cmp_gt_u32 vcc, 0x100, v8
    s_nop 1
    v_cndmask_b32 v114, v9, v114, vcc
    v_subrev_u32 v8, 11, v127
    v_cmp_gt_u32 vcc, 0x100, v8
    s_nop 1
    v_cndmask_b32 v115, v9, v115, vcc
    v_subrev_u32 v8, 16, v127
    v_cmp_gt_u32 vcc, 0x100, v8
    s_nop 1
    v_cndmask_b32 v116, v9, v116, vcc
    v_subrev_u32 v8, 17, v127
    v_cmp_gt_u32 vcc, 0x100, v8
    s_nop 1
    v_cndmask_b32 v117, v9, v117, vcc
    v_subrev_u32 v8, 18, v127
    v_cmp_gt_u32 vcc, 0x100, v8
    s_nop 1
    v_cndmask_b32 v118, v9, v118, vcc
    v_subrev_u32 v8, 19, v127
    v_cmp_gt_u32 vcc, 0x100, v8
    s_nop 1
    v_cndmask_b32 v119, v9, v119, vcc
    v_subrev_u32 v8, 24, v127
    v_cmp_gt_u32 vcc, 0x100, v8
    s_nop 1
    v_cndmask_b32 v120, v9, v120, vcc
    v_subrev_u32 v8, 25, v127
    v_cmp_gt_u32 vcc, 0x100, v8
    s_nop 1
    v_cndmask_b32 v121, v9, v121, vcc
    v_subrev_u32 v8, 26, v127
    v_cmp_gt_u32 vcc, 0x100, v8
    s_nop 1
    v_cndmask_b32 v122, v9, v122, vcc
    v_subrev_u32 v8, 27, v127
    v_cmp_gt_u32 vcc, 0x100, v8
    s_nop 1
    v_cndmask_b32 v123, v9, v123, vcc
    s_cmp_lg_u32 s58, 0
    s_cbranch_scc1 L_f2_81
    v_max_f32 v128, v128, v108
    v_max_f32 v128, v128, v109
    v_max_f32 v128, v128, v110
    v_max_f32 v128, v128, v111
    v_max_f32 v128, v128, v112
    v_max_f32 v128, v128, v113
    v_max_f32 v128, v128, v114
    v_max_f32 v128, v128, v115
    v_max_f32 v128, v128, v116
    v_max_f32 v128, v128, v117
    v_max_f32 v128, v128, v118
    v_max_f32 v128, v128, v119
    v_max_f32 v128, v128, v120
    v_max_f32 v128, v128, v121
    v_max_f32 v128, v128, v122
    v_max_f32 v128, v128, v123
    s_branch L_fd_82
L_f2_81:
    v_sub_f32 v108, v108, v128
    v_sub_f32 v109, v109, v128
    v_sub_f32 v110, v110, v128
    v_sub_f32 v111, v111, v128
    v_sub_f32 v112, v112, v128
    v_sub_f32 v113, v113, v128
    v_sub_f32 v114, v114, v128
    v_sub_f32 v115, v115, v128
    v_sub_f32 v116, v116, v128
    v_sub_f32 v117, v117, v128
    v_sub_f32 v118, v118, v128
    v_sub_f32 v119, v119, v128
    v_sub_f32 v120, v120, v128
    v_sub_f32 v121, v121, v128
    v_sub_f32 v122, v122, v128
    v_sub_f32 v123, v123, v128
    v_exp_f32 v108, v108
    v_exp_f32 v109, v109
    v_exp_f32 v110, v110
    v_exp_f32 v111, v111
    v_exp_f32 v112, v112
    v_exp_f32 v113, v113
    v_exp_f32 v114, v114
    v_exp_f32 v115, v115
    v_exp_f32 v116, v116
    v_exp_f32 v117, v117
    v_exp_f32 v118, v118
    v_exp_f32 v119, v119
    v_exp_f32 v120, v120
    v_exp_f32 v121, v121
    v_exp_f32 v122, v122
    v_exp_f32 v123, v123
    s_nop 0
    v_cvt_pk_bf16_f32 v140, v108, v109
    v_cvt_pk_bf16_f32 v141, v110, v111
    v_cvt_pk_bf16_f32 v142, v112, v113
    v_cvt_pk_bf16_f32 v143, v114, v115
    v_cvt_pk_bf16_f32 v144, v116, v117
    v_cvt_pk_bf16_f32 v145, v118, v119
    v_cvt_pk_bf16_f32 v146, v120, v121
    v_cvt_pk_bf16_f32 v147, v122, v123
    s_nop 1
    v_mfma_f32_32x32x16_bf16 v[204:219], v[60:63], v[140:143], v[204:219]
    v_mfma_f32_32x32x16_bf16 v[204:219], v[64:67], v[144:147], v[204:219]
    s_nop 7
    s_nop 7
L_fd_82:
    s_add_u32 s57, s57, 1
    s_cmp_le_u32 s57, 8
    s_cbranch_scc1 L_fb_80
    v_mov_b32 v9, v128
    s_nop 1
    v_permlane32_swap_b32 v128, v9
    v_max_f32 v128, v128, v9
    s_add_u32 s58, s58, 1
    s_cmp_lt_u32 s58, 2
    s_cbranch_scc1 L_fp_79
L_fbb_77:
    s_cmp_eq_u64 s[62:63], 0
    s_cbranch_scc1 L_fbe_78
    v_mov_b32 v254, 0
    v_mov_b32 v128, 0xff800000
    s_mov_b32 s58, 0
    s_sub_u32 s59, 7, s100
    s_cmp_eq_u32 s44, 0
    s_cselect_b32 s59, s59, 0
    v_mov_b32 v220, 0
    v_mov_b32 v221, 0
    v_mov_b32 v222, 0
    v_mov_b32 v223, 0
    v_mov_b32 v224, 0
    v_mov_b32 v225, 0
    v_mov_b32 v226, 0
    v_mov_b32 v227, 0
    v_mov_b32 v228, 0
    v_mov_b32 v229, 0
    v_mov_b32 v230, 0
    v_mov_b32 v231, 0
    v_mov_b32 v232, 0
    v_mov_b32 v233, 0
    v_mov_b32 v234, 0
    v_mov_b32 v235, 0
L_fp_83:
    s_mov_b32 s57, s59
L_fb_84:
    s_lshl_b32 s47, s57, 9
    v_add_u32 v124, s47, v2
    v_add_u32 v125, s47, v3
    v_add_u32 v126, s47, v4
    ds_read_b128 v[28:31], v124 offset:512
    ds_read_b64 v[32:33], v125 offset:512
    ds_read_b64_tr_b16 v[60:61], v126 offset:512
    ds_read_b64_tr_b16 v[62:63], v126 offset:640
    ds_read_b64_tr_b16 v[64:65], v126 offset:768
    ds_read_b64_tr_b16 v[66:67], v126 offset:896
    s_sub_u32 s47, 8, s57
    s_lshl_b32 s47, s47, 5
    v_and_b32 v8, 31, v1
    v_lshrrev_b32 v9, 5, v1
    v_lshlrev_b32 v9, 2, v9
    v_sub_u32 v8, v8, v9
    v_add_u32 v127, s47, v8
    v_mov_b32 v9, 0xff800000
    s_waitcnt lgkmcnt(0)
    v_mfma_f32_32x32x16_bf16 v[108:123], v[28:31], v[248:251], 0
    v_mfma_f32_32x32x16_bf16 v[108:123], v[32:35], v[252:255], v[108:123]
    s_nop 7
    s_nop 7
    v_subrev_u32 v8, 0, v127
    v_cmp_gt_u32 vcc, 0x100, v8
    s_nop 1
    v_cndmask_b32 v108, v9, v108, vcc
    v_subrev_u32 v8, 1, v127
    v_cmp_gt_u32 vcc, 0x100, v8
    s_nop 1
    v_cndmask_b32 v109, v9, v109, vcc
    v_subrev_u32 v8, 2, v127
    v_cmp_gt_u32 vcc, 0x100, v8
    s_nop 1
    v_cndmask_b32 v110, v9, v110, vcc
    v_subrev_u32 v8, 3, v127
    v_cmp_gt_u32 vcc, 0x100, v8
    s_nop 1
    v_cndmask_b32 v111, v9, v111, vcc
    v_subrev_u32 v8, 8, v127
    v_cmp_gt_u32 vcc, 0x100, v8
    s_nop 1
    v_cndmask_b32 v112, v9, v112, vcc
    v_subrev_u32 v8, 9, v127
    v_cmp_gt_u32 vcc, 0x100, v8
    s_nop 1
    v_cndmask_b32 v113, v9, v113, vcc
    v_subrev_u32 v8, 10, v127
    v_cmp_gt_u32 vcc, 0x100, v8
    s_nop 1
    v_cndmask_b32 v114, v9, v114, vcc
    v_subrev_u32 v8, 11, v127
    v_cmp_gt_u32 vcc, 0x100, v8
    s_nop 1
    v_cndmask_b32 v115, v9, v115, vcc
    v_subrev_u32 v8, 16, v127
    v_cmp_gt_u32 vcc, 0x100, v8
    s_nop 1
    v_cndmask_b32 v116, v9, v116, vcc
    v_subrev_u32 v8, 17, v127
    v_cmp_gt_u32 vcc, 0x100, v8
    s_nop 1
    v_cndmask_b32 v117, v9, v117, vcc
    v_subrev_u32 v8, 18, v127
    v_cmp_gt_u32 vcc, 0x100, v8
    s_nop 1
    v_cndmask_b32 v118, v9, v118, vcc
    v_subrev_u32 v8, 19, v127
    v_cmp_gt_u32 vcc, 0x100, v8
    s_nop 1
    v_cndmask_b32 v119, v9, v119, vcc
    v_subrev_u32 v8, 24, v127
    v_cmp_gt_u32 vcc, 0x100, v8
    s_nop 1
    v_cndmask_b32 v120, v9, v120, vcc
    v_subrev_u32 v8, 25, v127
    v_cmp_gt_u32 vcc, 0x100, v8
    s_nop 1
    v_cndmask_b32 v121, v9, v121, vcc
    v_subrev_u32 v8, 26, v127
    v_cmp_gt_u32 vcc, 0x100, v8
    s_nop 1
    v_cndmask_b32 v122, v9, v122, vcc
    v_subrev_u32 v8, 27, v127
    v_cmp_gt_u32 vcc, 0x100, v8
    s_nop 1
    v_cndmask_b32 v123, v9, v123, vcc
    s_cmp_lg_u32 s58, 0
    s_cbranch_scc1 L_f2_85
    v_max_f32 v128, v128, v108
    v_max_f32 v128, v128, v109
    v_max_f32 v128, v128, v110
    v_max_f32 v128, v128, v111
    v_max_f32 v128, v128, v112
    v_max_f32 v128, v128, v113
    v_max_f32 v128, v128, v114
    v_max_f32 v128, v128, v115
    v_max_f32 v128, v128, v116
    v_max_f32 v128, v128, v117
    v_max_f32 v128, v128, v118
    v_max_f32 v128, v128, v119
    v_max_f32 v128, v128, v120
    v_max_f32 v128, v128, v121
    v_max_f32 v128, v128, v122
    v_max_f32 v128, v128, v123
    s_branch L_fd_86
L_f2_85:
    v_sub_f32 v108, v108, v128
    v_sub_f32 v109, v109, v128
    v_sub_f32 v110, v110, v128
    v_sub_f32 v111, v111, v128
    v_sub_f32 v112, v112, v128
    v_sub_f32 v113, v113, v128
    v_sub_f32 v114, v114, v128
    v_sub_f32 v115, v115, v128
    v_sub_f32 v116, v116, v128
    v_sub_f32 v117, v117, v128
    v_sub_f32 v118, v118, v128
    v_sub_f32 v119, v119, v128
    v_sub_f32 v120, v120, v128
    v_sub_f32 v121, v121, v128
    v_sub_f32 v122, v122, v128
    v_sub_f32 v123, v123, v128
    v_exp_f32 v108, v108
    v_exp_f32 v109, v109
    v_exp_f32 v110, v110
    v_exp_f32 v111, v111
    v_exp_f32 v112, v112
    v_exp_f32 v113, v113
    v_exp_f32 v114, v114
    v_exp_f32 v115, v115
    v_exp_f32 v116, v116
    v_exp_f32 v117, v117
    v_exp_f32 v118, v118
    v_exp_f32 v119, v119
    v_exp_f32 v120, v120
    v_exp_f32 v121, v121
    v_exp_f32 v122, v122
    v_exp_f32 v123, v123
    s_nop 0
    v_cvt_pk_bf16_f32 v140, v108, v109
    v_cvt_pk_bf16_f32 v141, v110, v111
    v_cvt_pk_bf16_f32 v142, v112, v113
    v_cvt_pk_bf16_f32 v143, v114, v115
    v_cvt_pk_bf16_f32 v144, v116, v117
    v_cvt_pk_bf16_f32 v145, v118, v119
    v_cvt_pk_bf16_f32 v146, v120, v121
    v_cvt_pk_bf16_f32 v147, v122, v123
    s_nop 1
    v_mfma_f32_32x32x16_bf16 v[220:235], v[60:63], v[140:143], v[220:235]
    v_mfma_f32_32x32x16_bf16 v[220:235], v[64:67], v[144:147], v[220:235]
    s_nop 7
    s_nop 7
L_fd_86:
    s_add_u32 s57, s57, 1
    s_cmp_le_u32 s57, 8
    s_cbranch_scc1 L_fb_84
    v_mov_b32 v9, v128
    s_nop 1
    v_permlane32_swap_b32 v128, v9
    v_max_f32 v128, v128, v9
    s_add_u32 s58, s58, 1
    s_cmp_lt_u32 s58, 2
    s_cbranch_scc1 L_fp_83
L_fbe_78:
    s_branch L_aret_63
L_qg_50:
    v_mfma_f32_16x16x32_bf16 v[96:99], v[64:67], v[80:83], v[96:99]
    v_mfma_f32_16x16x32_bf16 v[100:103], v[68:71], v[80:83], v[100:103]
    v_mfma_f32_16x16x32_bf16 v[104:107], v[72:75], v[80:83], v[104:107]
    v_mfma_f32_16x16x32_bf16 v[108:111], v[76:79], v[80:83], v[108:111]
    v_mfma_f32_16x16x32_bf16 v[112:115], v[64:67], v[84:87], v[112:115]
    v_mfma_f32_16x16x32_bf16 v[116:119], v[68:71], v[84:87], v[116:119]
    s_nop 3
    v_mfma_f32_16x16x32_bf16 v[120:123], v[72:75], v[84:87], v[120:123]
    v_mul_f32 v96, v3, v96
    v_mul_f32 v97, v3, v97
    v_mul_f32 v98, v3, v98
    v_mul_f32 v99, v3, v99
    v_mul_f32 v100, v3, v100
    v_mul_f32 v101, v3, v101
    v_mfma_f32_16x16x32_bf16 v[124:127], v[76:79], v[84:87], v[124:127]
    v_mul_f32 v102, v3, v102
    v_mul_f32 v103, v3, v103
    v_cvt_pk_bf16_f32 v160, v96, v97
    v_cvt_pk_bf16_f32 v161, v98, v99
    v_cvt_pk_bf16_f32 v162, v100, v101
    v_cvt_pk_bf16_f32 v163, v102, v103
    v_mfma_f32_16x16x32_bf16 v[128:131], v[32:35], v[56:59], v[128:131]
    s_mov_b32 s47, 0
    s_nop 0
    v_permlane16_swap_b32 v160, v162
    v_permlane16_swap_b32 v161, v163
    buffer_store_dwordx4 v[160:163], v7, s[36:39], s47 offen offset:0 sc1
    v_mul_f32 v104, v3, v104
    v_mul_f32 v105, v3, v105
    v_mfma_f32_16x16x32_bf16 v[132:135], v[36:39], v[56:59], v[132:135]
    v_mul_f32 v106, v3, v106
    v_mul_f32 v107, v3, v107
    v_mul_f32 v108, v3, v108
    v_mul_f32 v109, v3, v109
    v_mul_f32 v110, v3, v110
    v_mul_f32 v111, v3, v111
    v_mfma_f32_16x16x32_bf16 v[136:139], v[40:43], v[56:59], v[136:139]
    v_cvt_pk_bf16_f32 v164, v104, v105
    v_cvt_pk_bf16_f32 v165, v106, v107
    v_cvt_pk_bf16_f32 v166, v108, v109
    v_cvt_pk_bf16_f32 v167, v110, v111
    s_mov_b32 s47, 131072
    s_nop 0
    v_permlane16_swap_b32 v164, v166
    v_mfma_f32_16x16x32_bf16 v[140:143], v[44:47], v[56:59], v[140:143]
    v_permlane16_swap_b32 v165, v167
    buffer_store_dwordx4 v[164:167], v7, s[36:39], s47 offen offset:0 sc1
    v_mfma_f32_16x16x32_bf16 v[128:131], v[64:67], v[88:91], v[128:131]
    v_mfma_f32_16x16x32_bf16 v[132:135], v[68:71], v[88:91], v[132:135]
    s_nop 3
    v_mfma_f32_16x16x32_bf16 v[136:139], v[72:75], v[88:91], v[136:139]
    v_mul_f32 v112, v3, v112
    v_mul_f32 v113, v3, v113
    v_mul_f32 v114, v3, v114
    v_mul_f32 v115, v3, v115
    v_mul_f32 v116, v3, v116
    v_mul_f32 v117, v3, v117
    v_mfma_f32_16x16x32_bf16 v[140:143], v[76:79], v[88:91], v[140:143]
    v_mul_f32 v118, v3, v118
    v_mul_f32 v119, v3, v119
    v_cvt_pk_bf16_f32 v168, v112, v113
    v_cvt_pk_bf16_f32 v169, v114, v115
    v_cvt_pk_bf16_f32 v170, v116, v117
    v_cvt_pk_bf16_f32 v171, v118, v119
    v_mfma_f32_16x16x32_bf16 v[144:147], v[32:35], v[60:63], v[144:147]
    s_mov_b32 s47, 0
    s_nop 0
    v_permlane16_swap_b32 v168, v170
    v_permlane16_swap_b32 v169, v171
    buffer_store_dwordx4 v[168:171], v7, s[36:39], s47 offen offset:256 sc1
    v_mul_f32 v120, v3, v120
    v_mul_f32 v121, v3, v121
    v_mfma_f32_16x16x32_bf16 v[148:151], v[36:39], v[60:63], v[148:151]
    v_mul_f32 v122, v3, v122
    v_mul_f32 v123, v3, v123
    v_mul_f32 v124, v3, v124
    v_mul_f32 v125, v3, v125
    v_mul_f32 v126, v3, v126
    v_mul_f32 v127, v3, v127
    v_mfma_f32_16x16x32_bf16 v[152:155], v[40:43], v[60:63], v[152:155]
    v_cvt_pk_bf16_f32 v172, v120, v121
    v_cvt_pk_bf16_f32 v173, v122, v123
    v_cvt_pk_bf16_f32 v174, v124, v125
    v_cvt_pk_bf16_f32 v175, v126, v127
    s_mov_b32 s47, 131072
    s_nop 0
    v_permlane16_swap_b32 v172, v174
    v_mfma_f32_16x16x32_bf16 v[156:159], v[44:47], v[60:63], v[156:159]
    v_permlane16_swap_b32 v173, v175
    buffer_store_dwordx4 v[172:175], v7, s[36:39], s47 offen offset:256 sc1
    v_mfma_f32_16x16x32_bf16 v[144:147], v[64:67], v[92:95], v[144:147]
    v_mfma_f32_16x16x32_bf16 v[148:151], v[68:71], v[92:95], v[148:151]
    s_nop 3
    v_mfma_f32_16x16x32_bf16 v[152:155], v[72:75], v[92:95], v[152:155]
    v_mul_f32 v128, v3, v128
    v_mul_f32 v129, v3, v129
    v_mul_f32 v130, v3, v130
    v_mul_f32 v131, v3, v131
    v_mul_f32 v132, v3, v132
    v_mul_f32 v133, v3, v133
    v_mul_f32 v134, v3, v134
    v_mul_f32 v135, v3, v135
    v_cvt_pk_bf16_f32 v176, v128, v129
    v_cvt_pk_bf16_f32 v177, v130, v131
    v_cvt_pk_bf16_f32 v178, v132, v133
    v_cvt_pk_bf16_f32 v179, v134, v135
    s_mov_b32 s47, 0
    s_nop 0
    v_permlane16_swap_b32 v176, v178
    v_permlane16_swap_b32 v177, v179
    buffer_store_dwordx4 v[176:179], v7, s[36:39], s47 offen offset:512 sc1
    v_mfma_f32_16x16x32_bf16 v[156:159], v[76:79], v[92:95], v[156:159]
    v_mul_f32 v136, v3, v136
    v_mul_f32 v137, v3, v137
    v_mul_f32 v138, v3, v138
    v_mul_f32 v139, v3, v139
    v_mul_f32 v140, v3, v140
    v_mul_f32 v141, v3, v141
    v_mul_f32 v142, v3, v142
    v_mul_f32 v143, v3, v143
    v_cvt_pk_bf16_f32 v180, v136, v137
    v_cvt_pk_bf16_f32 v181, v138, v139
    v_cvt_pk_bf16_f32 v182, v140, v141
    v_cvt_pk_bf16_f32 v183, v142, v143
    s_mov_b32 s47, 131072
    s_nop 0
    v_permlane16_swap_b32 v180, v182
    v_permlane16_swap_b32 v181, v183
    buffer_store_dwordx4 v[180:183], v7, s[36:39], s47 offen offset:512 sc1
    s_nop 3
    v_mul_f32 v144, v3, v144
    v_mul_f32 v145, v3, v145
    v_mul_f32 v146, v3, v146
    v_mul_f32 v147, v3, v147
    v_mul_f32 v148, v3, v148
    v_mul_f32 v149, v3, v149
    v_mul_f32 v150, v3, v150
    v_mul_f32 v151, v3, v151
    v_cvt_pk_bf16_f32 v184, v144, v145
    v_cvt_pk_bf16_f32 v185, v146, v147
    v_cvt_pk_bf16_f32 v186, v148, v149
    v_cvt_pk_bf16_f32 v187, v150, v151
    s_mov_b32 s47, 0
    s_nop 0
    v_permlane16_swap_b32 v184, v186
    v_permlane16_swap_b32 v185, v187
    buffer_store_dwordx4 v[184:187], v7, s[36:39], s47 offen offset:768 sc1
    v_mul_f32 v152, v3, v152
    v_mul_f32 v153, v3, v153
    v_mul_f32 v154, v3, v154
    v_mul_f32 v155, v3, v155
    v_mul_f32 v156, v3, v156
    v_mul_f32 v157, v3, v157
    v_mul_f32 v158, v3, v158
    v_mul_f32 v159, v3, v159
    v_cvt_pk_bf16_f32 v188, v152, v153
    v_cvt_pk_bf16_f32 v189, v154, v155
    v_cvt_pk_bf16_f32 v190, v156, v157
    v_cvt_pk_bf16_f32 v191, v158, v159
    s_mov_b32 s47, 131072
    s_nop 0
    v_permlane16_swap_b32 v188, v190
    v_permlane16_swap_b32 v189, v191
    buffer_store_dwordx4 v[188:191], v7, s[36:39], s47 offen offset:768 sc1
    s_branch L_qj_49
L_spare_3:
    s_and_b32 s50, s46, 3
    s_lshr_b32 s51, s46, 2
    s_and_b32 s52, s45, 1
    s_lshl_b32 s48, s52, 1
    s_add_u32 s49, s51, s48
    v_lshrrev_b32 v88, 4, v1
    v_lshlrev_b32 v89, 1, v88
    v_and_b32 v90, 15, v1
    v_xor_b32 v89, v89, v90
    v_mul_u32_u24 v88, 40960, v88
    v_and_b32 v90, 7, v89
    v_lshl_add_u32 v88, v90, 4, v88
    s_lshl_b32 s54, s44, 2
    s_add_u32 s54, s54, s50
    s_mul_i32 s54, s54, 1280
    s_lshl_b32 s48, s49, 7
    s_add_u32 s47, s54, s48
    v_add_u32 v88, s47, v88
    v_lshrrev_b32 v89, 3, v89
    v_mul_u32_u24 v90, 640, v89
    v_add_u32 v2, v88, v90
    v_sub_u32 v90, 640, v90
    v_add_u32 v3, v88, v90
    s_lshl_b32 s55, s46, 14
    s_waitcnt lgkmcnt(0)
    s_mov_b32 s56, s10
    s_mov_b32 s57, s11
    s_mov_b32 s58, 2621440
    s_mov_b32 s59, 0x20000
    s_lshl_b32 s66, s50, 3
    s_mov_b32 s65, s54
    s_mov_b32 s64, s55
    s_mov_b32 s67, 0
    s_add_u32 m0, s64, 0
    s_add_u32 s47, s67, 0
    buffer_load_dwordx4 v2, s[56:59], s47 offen  lds
    s_add_u32 m0, s64, 1024
    s_add_u32 s47, s67, 163840
    buffer_load_dwordx4 v2, s[56:59], s47 offen  lds
    v_bfe_u32 v152, v1, 1, 3
    v_add_u32 v152, 0, v152
    v_and_b32 v153, 1, v1
    v_cvt_f32_u32 v155, v152
    v_cvt_f32_u32 v156, v153
    v_lshl_add_u32 v152, v152, 1, v153
    v_mul_f32 v155, 1015021568, v155
    v_cmp_eq_u32 s[54:55], 1, v152
    v_mul_f32 v156, 1048576000, v156
    v_mov_b32 v153, 0.5
    v_cndmask_b32 v156, v156, 0, s[54:55]
    v_cndmask_b32 v155, v155, v153, s[54:55]
    v_lshrrev_b32 v157, 4, v1
    v_lshlrev_b32 v157, 3, v157
    v_cvt_f32_u32 v157, v157
    v_fma_f32 v156, v155, v157, v156
    v_fmamk_f32 v154, v155, 0, v156
    v_add_f32 v153, v155, v154
    v_cos_f32 v154, v154
    v_cos_f32 v153, v153
    s_nop 0
    v_cvt_pk_bf16_f32 v216, v154, v153
    v_fmamk_f32 v154, v155, 1073741824, v156
    v_add_f32 v153, v155, v154
    v_cos_f32 v154, v154
    v_cos_f32 v153, v153
    s_nop 0
    v_cvt_pk_bf16_f32 v217, v154, v153
    s_add_u32 m0, s64, 2048
    s_add_u32 s47, s67, 327680
    buffer_load_dwordx4 v3, s[56:59], s47 offen  lds
    v_fmamk_f32 v154, v155, 1082130432, v156
    v_add_f32 v153, v155, v154
    v_cos_f32 v154, v154
    v_cos_f32 v153, v153
    s_nop 0
    v_cvt_pk_bf16_f32 v218, v154, v153
    v_fmamk_f32 v154, v155, 1086324736, v156
    v_add_f32 v153, v155, v154
    v_cos_f32 v154, v154
    v_cos_f32 v153, v153
    s_nop 0
    v_cvt_pk_bf16_f32 v219, v154, v153
    v_fmamk_f32 v154, v155, 1107296256, v156
    v_add_f32 v153, v155, v154
    v_cos_f32 v154, v154
    v_cos_f32 v153, v153
    s_nop 0
    v_cvt_pk_bf16_f32 v220, v154, v153
    s_add_u32 m0, s64, 3072
    s_add_u32 s47, s67, 491520
    buffer_load_dwordx4 v3, s[56:59], s47 offen  lds
    v_fmamk_f32 v154, v155, 1107820544, v156
    v_add_f32 v153, v155, v154
    v_cos_f32 v154, v154
    v_cos_f32 v153, v153
    s_nop 0
    v_cvt_pk_bf16_f32 v221, v154, v153
    v_fmamk_f32 v154, v155, 1108344832, v156
    v_add_f32 v153, v155, v154
    v_cos_f32 v154, v154
    v_cos_f32 v153, v153
    s_nop 0
    v_cvt_pk_bf16_f32 v222, v154, v153
    v_fmamk_f32 v154, v155, 1108869120, v156
    v_add_f32 v153, v155, v154
    v_cos_f32 v154, v154
    v_cos_f32 v153, v153
    s_nop 0
    v_cvt_pk_bf16_f32 v223, v154, v153
    s_add_u32 m0, s64, 4096
    s_add_u32 s47, s67, 655360
    buffer_load_dwordx4 v2, s[56:59], s47 offen  lds
    v_bfe_u32 v152, v1, 1, 3
    v_add_u32 v152, 8, v152
    v_and_b32 v153, 1, v1
    v_cvt_f32_u32 v155, v152
    v_cvt_f32_u32 v156, v153
    v_lshl_add_u32 v152, v152, 1, v153
    v_mul_f32 v155, 1015021568, v155
    v_cmp_eq_u32 s[54:55], 1, v152
    v_mul_f32 v156, 1048576000, v156
    v_mov_b32 v153, 0.5
    v_cndmask_b32 v156, v156, 0, s[54:55]
    v_cndmask_b32 v155, v155, v153, s[54:55]
    v_lshrrev_b32 v157, 4, v1
    v_lshlrev_b32 v157, 3, v157
    v_cvt_f32_u32 v157, v157
    v_fma_f32 v156, v155, v157, v156
    v_fmamk_f32 v154, v155, 0, v156
    v_add_f32 v153, v155, v154
    v_cos_f32 v154, v154
    v_cos_f32 v153, v153
    s_nop 0
    v_cvt_pk_bf16_f32 v224, v154, v153
    v_fmamk_f32 v154, v155, 1073741824, v156
    v_add_f32 v153, v155, v154
    v_cos_f32 v154, v154
    v_cos_f32 v153, v153
    s_nop 0
    v_cvt_pk_bf16_f32 v225, v154, v153
    s_add_u32 m0, s64, 5120
    s_add_u32 s47, s67, 819200
    buffer_load_dwordx4 v2, s[56:59], s47 offen  lds
    v_fmamk_f32 v154, v155, 1082130432, v156
    v_add_f32 v153, v155, v154
    v_cos_f32 v154, v154
    v_cos_f32 v153, v153
    s_nop 0
    v_cvt_pk_bf16_f32 v226, v154, v153
    v_fmamk_f32 v154, v155, 1086324736, v156
    v_add_f32 v153, v155, v154
    v_cos_f32 v154, v154
    v_cos_f32 v153, v153
    s_nop 0
    v_cvt_pk_bf16_f32 v227, v154, v153
    v_fmamk_f32 v154, v155, 1107296256, v156
    v_add_f32 v153, v155, v154
    v_cos_f32 v154, v154
    v_cos_f32 v153, v153
    s_nop 0
    v_cvt_pk_bf16_f32 v228, v154, v153
    s_add_u32 m0, s64, 6144
    s_add_u32 s47, s67, 983040
    buffer_load_dwordx4 v3, s[56:59], s47 offen  lds
    v_fmamk_f32 v154, v155, 1107820544, v156
    v_add_f32 v153, v155, v154
    v_cos_f32 v154, v154
    v_cos_f32 v153, v153
    s_nop 0
    v_cvt_pk_bf16_f32 v229, v154, v153
    v_fmamk_f32 v154, v155, 1108344832, v156
    v_add_f32 v153, v155, v154
    v_cos_f32 v154, v154
    v_cos_f32 v153, v153
    s_nop 0
    v_cvt_pk_bf16_f32 v230, v154, v153
    v_fmamk_f32 v154, v155, 1108869120, v156
    v_add_f32 v153, v155, v154
    v_cos_f32 v154, v154
    v_cos_f32 v153, v153
    s_nop 0
    v_cvt_pk_bf16_f32 v231, v154, v153
    s_add_u32 m0, s64, 7168
    s_add_u32 s47, s67, 1146880
    buffer_load_dwordx4 v3, s[56:59], s47 offen  lds
    v_bfe_u32 v152, v1, 1, 3
    v_add_u32 v152, 16, v152
    v_and_b32 v153, 1, v1
    v_cvt_f32_u32 v155, v152
    v_cvt_f32_u32 v156, v153
    v_lshl_add_u32 v152, v152, 1, v153
    v_mul_f32 v155, 1015021568, v155
    v_cmp_eq_u32 s[54:55], 1, v152
    v_mul_f32 v156, 1048576000, v156
    v_mov_b32 v153, 0.5
    v_cndmask_b32 v156, v156, 0, s[54:55]
    v_cndmask_b32 v155, v155, v153, s[54:55]
    v_lshrrev_b32 v157, 4, v1
    v_lshlrev_b32 v157, 3, v157
    v_cvt_f32_u32 v157, v157
    v_fma_f32 v156, v155, v157, v156
    v_fmamk_f32 v154, v155, 0, v156
    v_add_f32 v153, v155, v154
    v_cos_f32 v154, v154
    v_cos_f32 v153, v153
    s_nop 0
    v_cvt_pk_bf16_f32 v232, v154, v153
    v_fmamk_f32 v154, v155, 1073741824, v156
    v_add_f32 v153, v155, v154
    v_cos_f32 v154, v154
    v_cos_f32 v153, v153
    s_nop 0
    v_cvt_pk_bf16_f32 v233, v154, v153
    s_add_u32 m0, s64, 8192
    s_add_u32 s47, s67, 1310720
    buffer_load_dwordx4 v2, s[56:59], s47 offen  lds
    v_fmamk_f32 v154, v155, 1082130432, v156
    v_add_f32 v153, v155, v154
    v_cos_f32 v154, v154
    v_cos_f32 v153, v153
    s_nop 0
    v_cvt_pk_bf16_f32 v234, v154, v153
    v_fmamk_f32 v154, v155, 1086324736, v156
    v_add_f32 v153, v155, v154
    v_cos_f32 v154, v154
    v_cos_f32 v153, v153
    s_nop 0
    v_cvt_pk_bf16_f32 v235, v154, v153
    v_fmamk_f32 v154, v155, 1107296256, v156
    v_add_f32 v153, v155, v154
    v_cos_f32 v154, v154
    v_cos_f32 v153, v153
    s_nop 0
    v_cvt_pk_bf16_f32 v236, v154, v153
    s_add_u32 m0, s64, 9216
    s_add_u32 s47, s67, 1474560
    buffer_load_dwordx4 v2, s[56:59], s47 offen  lds
    v_fmamk_f32 v154, v155, 1107820544, v156
    v_add_f32 v153, v155, v154
    v_cos_f32 v154, v154
    v_cos_f32 v153, v153
    s_nop 0
    v_cvt_pk_bf16_f32 v237, v154, v153
    v_fmamk_f32 v154, v155, 1108344832, v156
    v_add_f32 v153, v155, v154
    v_cos_f32 v154, v154
    v_cos_f32 v153, v153
    s_nop 0
    v_cvt_pk_bf16_f32 v238, v154, v153
    v_fmamk_f32 v154, v155, 1108869120, v156
    v_add_f32 v153, v155, v154
    v_cos_f32 v154, v154
    v_cos_f32 v153, v153
    s_nop 0
    v_cvt_pk_bf16_f32 v239, v154, v153
    s_add_u32 m0, s64, 10240
    s_add_u32 s47, s67, 1638400
    buffer_load_dwordx4 v3, s[56:59], s47 offen  lds
    v_bfe_u32 v152, v1, 1, 3
    v_add_u32 v152, 24, v152
    v_and_b32 v153, 1, v1
    v_cvt_f32_u32 v155, v152
    v_cvt_f32_u32 v156, v153
    v_lshl_add_u32 v152, v152, 1, v153
    v_mul_f32 v155, 1015021568, v155
    v_cmp_eq_u32 s[54:55], 1, v152
    v_mul_f32 v156, 1048576000, v156
    v_mov_b32 v153, 0.5
    v_cndmask_b32 v156, v156, 0, s[54:55]
    v_cndmask_b32 v155, v155, v153, s[54:55]
    v_lshrrev_b32 v157, 4, v1
    v_lshlrev_b32 v157, 3, v157
    v_cvt_f32_u32 v157, v157
    v_fma_f32 v156, v155, v157, v156
    v_fmamk_f32 v154, v155, 0, v156
    v_add_f32 v153, v155, v154
    v_cos_f32 v154, v154
    v_cos_f32 v153, v153
    s_nop 0
    v_cvt_pk_bf16_f32 v240, v154, v153
    v_fmamk_f32 v154, v155, 1073741824, v156
    v_add_f32 v153, v155, v154
    v_cos_f32 v154, v154
    v_cos_f32 v153, v153
    s_nop 0
    v_cvt_pk_bf16_f32 v241, v154, v153
    s_add_u32 m0, s64, 11264
    s_add_u32 s47, s67, 1802240
    buffer_load_dwordx4 v3, s[56:59], s47 offen  lds
    v_fmamk_f32 v154, v155, 1082130432, v156
    v_add_f32 v153, v155, v154
    v_cos_f32 v154, v154
    v_cos_f32 v153, v153
    s_nop 0
    v_cvt_pk_bf16_f32 v242, v154, v153
    v_fmamk_f32 v154, v155, 1086324736, v156
    v_add_f32 v153, v155, v154
    v_cos_f32 v154, v154
    v_cos_f32 v153, v153
    s_nop 0
    v_cvt_pk_bf16_f32 v243, v154, v153
    v_fmamk_f32 v154, v155, 1107296256, v156
    v_add_f32 v153, v155, v154
    v_cos_f32 v154, v154
    v_cos_f32 v153, v153
    s_nop 0
    v_cvt_pk_bf16_f32 v244, v154, v153
    s_add_u32 m0, s64, 12288
    s_add_u32 s47, s67, 1966080
    buffer_load_dwordx4 v2, s[56:59], s47 offen  lds
    v_fmamk_f32 v154, v155, 1107820544, v156
    v_add_f32 v153, v155, v154
    v_cos_f32 v154, v154
    v_cos_f32 v153, v153
    s_nop 0
    v_cvt_pk_bf16_f32 v245, v154, v153
    v_fmamk_f32 v154, v155, 1108344832, v156
    v_add_f32 v153, v155, v154
    v_cos_f32 v154, v154
    v_cos_f32 v153, v153
    s_nop 0
    v_cvt_pk_bf16_f32 v246, v154, v153
    v_fmamk_f32 v154, v155, 1108869120, v156
    v_add_f32 v153, v155, v154
    v_cos_f32 v154, v154
    v_cos_f32 v153, v153
    s_nop 0
    v_cvt_pk_bf16_f32 v247, v154, v153
    s_add_u32 m0, s64, 13312
    s_add_u32 s47, s67, 2129920
    buffer_load_dwordx4 v2, s[56:59], s47 offen  lds
    v_bfe_u32 v152, v1, 1, 3
    v_add_u32 v152, s66, v152
    v_and_b32 v153, 1, v1
    v_cvt_f32_u32 v155, v152
    v_cvt_f32_u32 v156, v153
    v_lshl_add_u32 v152, v152, 1, v153
    v_mul_f32 v155, 1015021568, v155
    v_cmp_eq_u32 s[54:55], 1, v152
    v_mul_f32 v156, 1048576000, v156
    v_mov_b32 v153, 0.5
    v_cndmask_b32 v156, v156, 0, s[54:55]
    v_cndmask_b32 v155, v155, v153, s[54:55]
    v_lshrrev_b32 v157, 4, v1
    v_lshlrev_b32 v157, 3, v157
    v_cvt_f32_u32 v157, v157
    v_fma_f32 v156, v155, v157, v156
    v_fmamk_f32 v154, v155, 0, v156
    v_add_f32 v153, v155, v154
    v_cos_f32 v154, v154
    v_cos_f32 v153, v153
    s_nop 0
    v_cvt_pk_bf16_f32 v248, v154, v153
    v_fmamk_f32 v154, v155, 1073741824, v156
    v_add_f32 v153, v155, v154
    v_cos_f32 v154, v154
    v_cos_f32 v153, v153
    s_nop 0
    v_cvt_pk_bf16_f32 v249, v154, v153
    s_add_u32 m0, s64, 14336
    s_add_u32 s47, s67, 2293760
    buffer_load_dwordx4 v3, s[56:59], s47 offen  lds
    v_fmamk_f32 v154, v155, 1082130432, v156
    v_add_f32 v153, v155, v154
    v_cos_f32 v154, v154
    v_cos_f32 v153, v153
    s_nop 0
    v_cvt_pk_bf16_f32 v250, v154, v153
    v_fmamk_f32 v154, v155, 1086324736, v156
    v_add_f32 v153, v155, v154
    v_cos_f32 v154, v154
    v_cos_f32 v153, v153
    s_nop 0
    v_cvt_pk_bf16_f32 v251, v154, v153
    v_fmamk_f32 v154, v155, 1107296256, v156
    v_add_f32 v153, v155, v154
    v_cos_f32 v154, v154
    v_cos_f32 v153, v153
    s_nop 0
    v_cvt_pk_bf16_f32 v252, v154, v153
    s_add_u32 m0, s64, 15360
    s_add_u32 s47, s67, 2457600
    buffer_load_dwordx4 v3, s[56:59], s47 offen  lds
    v_fmamk_f32 v154, v155, 1107820544, v156
    v_add_f32 v153, v155, v154
    v_cos_f32 v154, v154
    v_cos_f32 v153, v153
    s_nop 0
    v_cvt_pk_bf16_f32 v253, v154, v153
    v_fmamk_f32 v154, v155, 1108344832, v156
    v_add_f32 v153, v155, v154
    v_cos_f32 v154, v154
    v_cos_f32 v153, v153
    s_nop 0
    v_cvt_pk_bf16_f32 v254, v154, v153
    v_fmamk_f32 v154, v155, 1108869120, v156
    v_add_f32 v153, v155, v154
    v_cos_f32 v154, v154
    v_cos_f32 v153, v153
    s_nop 0
    v_cvt_pk_bf16_f32 v255, v154, v153
    v_lshrrev_b32 v88, 3, v1
    v_mul_u32_u24 v88, 40960, v88
    v_bfe_u32 v89, v1, 4, 1
    v_bfe_u32 v90, v1, 1, 1
    v_xor_b32 v89, v89, v90
    v_lshl_add_u32 v88, v89, 5, v88
    v_and_b32 v89, 1, v1
    v_lshl_add_u32 v88, v89, 4, v88
    s_mul_i32 s47, s51, 1310720
    s_add_u32 s47, s47, s65
    s_lshl_b32 s48, s52, 6
    s_add_u32 s47, s47, s48
    s_add_u32 s47, s47, 512
    v_add_u32 v88, s47, v88
    v_bfe_u32 v89, v1, 2, 1
    v_mul_u32_u24 v90, 640, v89
    v_add_u32 v4, v88, v90
    v_sub_u32 v90, 640, v90
    v_add_u32 v5, v88, v90
    s_lshl_b32 s55, s50, 13
    s_lshl_b32 s48, s51, 12
    s_add_u32 s55, s55, s48
    s_mov_b32 s68, s55
    s_mov_b32 s69, 0
    s_add_u32 m0, s68, 131072
    s_sub_u32 s47, 0, s69
    buffer_load_dwordx4 v4, s[56:59], s47 offen  lds
    s_add_u32 m0, s68, 132096
    s_sub_u32 s47, 327680, s69
    buffer_load_dwordx4 v5, s[56:59], s47 offen  lds
    s_add_u32 m0, s68, 133120
    s_sub_u32 s47, 655360, s69
    buffer_load_dwordx4 v4, s[56:59], s47 offen  lds
    s_add_u32 m0, s68, 134144
    s_sub_u32 s47, 983040, s69
    buffer_load_dwordx4 v5, s[56:59], s47 offen  lds
    s_mov_b32 s36, s24
    s_mov_b32 s37, s25
    s_mov_b32 s38, 16777216
    s_mov_b32 s39, 0x20000
    s_mov_b32 s47, 14811136
    s_load_dword s26, s[36:37], s47
    v_lshrrev_b32 v88, 4, v1
    v_bfe_u32 v89, v1, 2, 2
    v_lshl_add_u32 v90, v88, 3, v89
    v_and_b32 v91, 3, v1
    v_lshlrev_b32 v91, 3, v91
    v_lshl_add_u32 v6, v90, 8, v91
    v_lshl_add_u32 v10, v90, 7, v91
    v_mul_u32_u24 v12, 163840, v88
    v_and_b32 v88, 1, v88
    v_lshl_add_u32 v90, v88, 2, v89
    v_xor_b32 v90, s50, v90
    v_lshl_add_u32 v6, v90, 5, v6
    s_lshl_b32 s47, s51, 16
    v_add_u32 v6, s47, v6
    v_xor_b32 v7, 128, v6
    v_lshrrev_b32 v89, 1, v89
    v_lshl_add_u32 v89, v88, 1, v89
    v_xor_b32 v89, s51, v89
    v_lshl_add_u32 v10, v89, 5, v10
    v_add_u32 v10, 131072, v10
    v_xor_b32 v11, 64, v10
    v_and_b32 v88, 15, v1
    v_lshl_add_u32 v12, v88, 4, v12
    s_mul_i32 s47, s44, 10240
    s_add_u32 s48, s49, 16
    s_lshl_b32 s48, s48, 8
    s_add_u32 s48, s48, s47
    s_mul_i32 s54, s50, 655360
    s_add_u32 s48, s48, s54
    v_add_u32 v13, s48, v12
    s_lshl_b32 s48, s49, 2
    s_add_u32 s48, s48, s50
    s_lshl_b32 s48, s48, 8
    s_add_u32 s48, s48, s47
    v_add_u32 v12, s48, v12
    s_waitcnt lgkmcnt(0)
    s_mul_i32 s26, s26, 1664525
    s_add_u32 s26, s26, 1013904223
    s_waitcnt vmcnt(4)
    s_barrier
    s_getreg_b32 s48, hwreg(HW_REG_XCC_ID, 0, 4)
    s_add_u32 s48, s48, s26
    s_add_u32 s48, s48, 1
    s_lshl_b32 s47, s2, 7
    s_add_u32 s47, s47, 14778368
    s_cmp_eq_u32 s46, 0
    s_cselect_b32 s47, s47, 16777216
    v_mov_b32 v17, s47
    v_mov_b32 v18, s48
    s_mov_b64 exec, 1
    buffer_store_dword v18, v17, s[36:39], 0 offen sc1
    s_mov_b64 exec, -1
    ds_read_b64_tr_b16 v[24:25], v6 offset:0
    ds_read_b64_tr_b16 v[26:27], v6 offset:1024
    ds_read_b64_tr_b16 v[28:29], v7 offset:0
    ds_read_b64_tr_b16 v[30:31], v7 offset:1024
    ds_read_b64_tr_b16 v[40:41], v6 offset:16384
    ds_read_b64_tr_b16 v[42:43], v6 offset:17408
    ds_read_b64_tr_b16 v[44:45], v7 offset:16384
    ds_read_b64_tr_b16 v[46:47], v7 offset:17408
    ds_read_b64_tr_b16 v[56:57], v6 offset:32768
    ds_read_b64_tr_b16 v[58:59], v6 offset:33792
    ds_read_b64_tr_b16 v[60:61], v7 offset:32768
    ds_read_b64_tr_b16 v[62:63], v7 offset:33792
    ds_read_b64_tr_b16 v[72:73], v6 offset:49152
    ds_read_b64_tr_b16 v[74:75], v6 offset:50176
    ds_read_b64_tr_b16 v[76:77], v7 offset:49152
    ds_read_b64_tr_b16 v[78:79], v7 offset:50176
    ds_read_b64_tr_b16 v[32:33], v6 offset:8192
    ds_read_b64_tr_b16 v[34:35], v6 offset:9216
    ds_read_b64_tr_b16 v[36:37], v7 offset:8192
    ds_read_b64_tr_b16 v[38:39], v7 offset:9216
    ds_read_b64_tr_b16 v[48:49], v6 offset:24576
    ds_read_b64_tr_b16 v[50:51], v6 offset:25600
    ds_read_b64_tr_b16 v[52:53], v7 offset:24576
    ds_read_b64_tr_b16 v[54:55], v7 offset:25600
    ds_read_b64_tr_b16 v[64:65], v6 offset:40960
    ds_read_b64_tr_b16 v[66:67], v6 offset:41984
    ds_read_b64_tr_b16 v[68:69], v7 offset:40960
    ds_read_b64_tr_b16 v[70:71], v7 offset:41984
    ds_read_b64_tr_b16 v[80:81], v6 offset:57344
    ds_read_b64_tr_b16 v[82:83], v6 offset:58368
    ds_read_b64_tr_b16 v[84:85], v7 offset:57344
    ds_read_b64_tr_b16 v[86:87], v7 offset:58368
    s_waitcnt lgkmcnt(15)
    v_mfma_f32_16x16x32_bf16 v[152:155], v[216:219], v[24:27], 0
    v_mfma_f32_16x16x32_bf16 v[156:159], v[216:219], v[28:31], 0
    v_mfma_f32_16x16x32_bf16 v[160:163], v[216:219], v[40:43], 0
    v_mfma_f32_16x16x32_bf16 v[164:167], v[216:219], v[44:47], 0
    v_mfma_f32_16x16x32_bf16 v[168:171], v[216:219], v[56:59], 0
    v_mfma_f32_16x16x32_bf16 v[172:175], v[216:219], v[60:63], 0
    v_mfma_f32_16x16x32_bf16 v[176:179], v[216:219], v[72:75], 0
    v_mfma_f32_16x16x32_bf16 v[180:183], v[216:219], v[76:79], 0
    s_waitcnt lgkmcnt(0)
    v_mfma_f32_16x16x32_bf16 v[152:155], v[220:223], v[32:35], v[152:155]
    v_mfma_f32_16x16x32_bf16 v[156:159], v[220:223], v[36:39], v[156:159]
    v_mfma_f32_16x16x32_bf16 v[160:163], v[220:223], v[48:51], v[160:163]
    v_mfma_f32_16x16x32_bf16 v[164:167], v[220:223], v[52:55], v[164:167]
    v_mfma_f32_16x16x32_bf16 v[168:171], v[220:223], v[64:67], v[168:171]
    v_mfma_f32_16x16x32_bf16 v[172:175], v[220:223], v[68:71], v[172:175]
    v_mfma_f32_16x16x32_bf16 v[176:179], v[220:223], v[80:83], v[176:179]
    v_mfma_f32_16x16x32_bf16 v[180:183], v[220:223], v[84:87], v[180:183]
    s_nop 0
    v_mfma_f32_16x16x32_bf16 v[184:187], v[224:227], v[24:27], 0
    v_add_f32 v16, v152, v156
    v_add_f32 v17, v153, v157
    v_sub_f32 v18, v152, v156
    v_sub_f32 v19, v153, v157
    v_mfma_f32_16x16x32_bf16 v[188:191], v[224:227], v[28:31], 0
    v_cvt_pk_bf16_f32 v136, v16, v17
    v_cvt_pk_bf16_f32 v144, v18, v19
    v_mfma_f32_16x16x32_bf16 v[192:195], v[224:227], v[40:43], 0
    v_add_f32 v20, v160, v164
    v_add_f32 v21, v161, v165
    v_sub_f32 v22, v160, v164
    v_sub_f32 v23, v161, v165
    v_mfma_f32_16x16x32_bf16 v[196:199], v[224:227], v[44:47], 0
    v_cvt_pk_bf16_f32 v137, v20, v21
    v_cvt_pk_bf16_f32 v145, v22, v23
    v_mfma_f32_16x16x32_bf16 v[200:203], v[224:227], v[56:59], 0
    v_add_f32 v16, v168, v172
    v_add_f32 v17, v169, v173
    v_sub_f32 v18, v168, v172
    v_sub_f32 v19, v169, v173
    v_mfma_f32_16x16x32_bf16 v[204:207], v[224:227], v[60:63], 0
    v_cvt_pk_bf16_f32 v138, v16, v17
    v_cvt_pk_bf16_f32 v146, v18, v19
    v_mfma_f32_16x16x32_bf16 v[208:211], v[224:227], v[72:75], 0
    v_add_f32 v20, v176, v180
    v_add_f32 v21, v177, v181
    v_sub_f32 v22, v176, v180
    v_sub_f32 v23, v177, v181
    v_mfma_f32_16x16x32_bf16 v[212:215], v[224:227], v[76:79], 0
    v_cvt_pk_bf16_f32 v139, v20, v21
    v_cvt_pk_bf16_f32 v147, v22, v23
    s_mov_b32 s47, 11534336
    buffer_store_dwordx4 v[136:139], v12, s[36:39], s47 offen sc1
    s_mov_b32 s47, 11539456
    buffer_store_dwordx4 v[144:147], v12, s[36:39], s47 offen sc1
    v_mfma_f32_16x16x32_bf16 v[184:187], v[228:231], v[32:35], v[184:187]
    v_add_f32 v16, v154, v158
    v_add_f32 v17, v155, v159
    v_sub_f32 v18, v154, v158
    v_sub_f32 v19, v155, v159
    v_mfma_f32_16x16x32_bf16 v[188:191], v[228:231], v[36:39], v[188:191]
    v_cvt_pk_bf16_f32 v140, v16, v17
    v_cvt_pk_bf16_f32 v148, v18, v19
    v_mfma_f32_16x16x32_bf16 v[192:195], v[228:231], v[48:51], v[192:195]
    v_add_f32 v20, v162, v166
    v_add_f32 v21, v163, v167
    v_sub_f32 v22, v162, v166
    v_sub_f32 v23, v163, v167
    v_mfma_f32_16x16x32_bf16 v[196:199], v[228:231], v[52:55], v[196:199]
    v_cvt_pk_bf16_f32 v141, v20, v21
    v_cvt_pk_bf16_f32 v149, v22, v23
    v_mfma_f32_16x16x32_bf16 v[200:203], v[228:231], v[64:67], v[200:203]
    v_add_f32 v16, v170, v174
    v_add_f32 v17, v171, v175
    v_sub_f32 v18, v170, v174
    v_sub_f32 v19, v171, v175
    v_mfma_f32_16x16x32_bf16 v[204:207], v[228:231], v[68:71], v[204:207]
    v_cvt_pk_bf16_f32 v142, v16, v17
    v_cvt_pk_bf16_f32 v150, v18, v19
    v_mfma_f32_16x16x32_bf16 v[208:211], v[228:231], v[80:83], v[208:211]
    v_add_f32 v20, v178, v182
    v_add_f32 v21, v179, v183
    v_sub_f32 v22, v178, v182
    v_sub_f32 v23, v179, v183
    v_mfma_f32_16x16x32_bf16 v[212:215], v[228:231], v[84:87], v[212:215]
    v_cvt_pk_bf16_f32 v143, v20, v21
    v_cvt_pk_bf16_f32 v151, v22, v23
    s_mov_b32 s47, 11616256
    buffer_store_dwordx4 v[140:143], v12, s[36:39], s47 offen sc1
    s_mov_b32 s47, 11621376
    buffer_store_dwordx4 v[148:151], v12, s[36:39], s47 offen sc1
    v_mfma_f32_16x16x32_bf16 v[152:155], v[232:235], v[24:27], 0
    v_add_f32 v16, v184, v188
    v_add_f32 v17, v185, v189
    v_sub_f32 v18, v184, v188
    v_sub_f32 v19, v185, v189
    v_mfma_f32_16x16x32_bf16 v[156:159], v[232:235], v[28:31], 0
    v_cvt_pk_bf16_f32 v136, v16, v17
    v_cvt_pk_bf16_f32 v144, v18, v19
    v_mfma_f32_16x16x32_bf16 v[160:163], v[232:235], v[40:43], 0
    v_add_f32 v20, v192, v196
    v_add_f32 v21, v193, v197
    v_sub_f32 v22, v192, v196
    v_sub_f32 v23, v193, v197
    v_mfma_f32_16x16x32_bf16 v[164:167], v[232:235], v[44:47], 0
    v_cvt_pk_bf16_f32 v137, v20, v21
    v_cvt_pk_bf16_f32 v145, v22, v23
    v_mfma_f32_16x16x32_bf16 v[168:171], v[232:235], v[56:59], 0
    v_add_f32 v16, v200, v204
    v_add_f32 v17, v201, v205
    v_sub_f32 v18, v200, v204
    v_sub_f32 v19, v201, v205
    v_mfma_f32_16x16x32_bf16 v[172:175], v[232:235], v[60:63], 0
    v_cvt_pk_bf16_f32 v138, v16, v17
    v_cvt_pk_bf16_f32 v146, v18, v19
    v_mfma_f32_16x16x32_bf16 v[176:179], v[232:235], v[72:75], 0
    v_add_f32 v20, v208, v212
    v_add_f32 v21, v209, v213
    v_sub_f32 v22, v208, v212
    v_sub_f32 v23, v209, v213
    v_mfma_f32_16x16x32_bf16 v[180:183], v[232:235], v[76:79], 0
    v_cvt_pk_bf16_f32 v139, v20, v21
    v_cvt_pk_bf16_f32 v147, v22, v23
    s_mov_b32 s47, 12189696
    buffer_store_dwordx4 v[136:139], v12, s[36:39], s47 offen sc1
    s_mov_b32 s47, 12194816
    buffer_store_dwordx4 v[144:147], v12, s[36:39], s47 offen sc1
    v_mfma_f32_16x16x32_bf16 v[152:155], v[236:239], v[32:35], v[152:155]
    v_add_f32 v16, v186, v190
    v_add_f32 v17, v187, v191
    v_sub_f32 v18, v186, v190
    v_sub_f32 v19, v187, v191
    v_mfma_f32_16x16x32_bf16 v[156:159], v[236:239], v[36:39], v[156:159]
    v_cvt_pk_bf16_f32 v140, v16, v17
    v_cvt_pk_bf16_f32 v148, v18, v19
    v_mfma_f32_16x16x32_bf16 v[160:163], v[236:239], v[48:51], v[160:163]
    v_add_f32 v20, v194, v198
    v_add_f32 v21, v195, v199
    v_sub_f32 v22, v194, v198
    v_sub_f32 v23, v195, v199
    v_mfma_f32_16x16x32_bf16 v[164:167], v[236:239], v[52:55], v[164:167]
    v_cvt_pk_bf16_f32 v141, v20, v21
    v_cvt_pk_bf16_f32 v149, v22, v23
    v_mfma_f32_16x16x32_bf16 v[168:171], v[236:239], v[64:67], v[168:171]
    v_add_f32 v16, v202, v206
    v_add_f32 v17, v203, v207
    v_sub_f32 v18, v202, v206
    v_sub_f32 v19, v203, v207
    v_mfma_f32_16x16x32_bf16 v[172:175], v[236:239], v[68:71], v[172:175]
    v_cvt_pk_bf16_f32 v142, v16, v17
    v_cvt_pk_bf16_f32 v150, v18, v19
    v_mfma_f32_16x16x32_bf16 v[176:179], v[236:239], v[80:83], v[176:179]
    v_add_f32 v20, v210, v214
    v_add_f32 v21, v211, v215
    v_sub_f32 v22, v210, v214
    v_sub_f32 v23, v211, v215
    v_mfma_f32_16x16x32_bf16 v[180:183], v[236:239], v[84:87], v[180:183]
    v_cvt_pk_bf16_f32 v143, v20, v21
    v_cvt_pk_bf16_f32 v151, v22, v23
    s_mov_b32 s47, 12271616
    buffer_store_dwordx4 v[140:143], v12, s[36:39], s47 offen sc1
    s_mov_b32 s47, 12276736
    buffer_store_dwordx4 v[148:151], v12, s[36:39], s47 offen sc1
    s_waitcnt vmcnt(8)
    s_barrier
    v_mfma_f32_16x16x32_bf16 v[184:187], v[240:243], v[24:27], 0
    ds_read_b64_tr_b16 v[24:25], v10 offset:0
    ds_read_b64_tr_b16 v[26:27], v10 offset:512
    v_add_f32 v16, v152, v156
    v_add_f32 v17, v153, v157
    v_sub_f32 v18, v152, v156
    v_sub_f32 v19, v153, v157
    v_mfma_f32_16x16x32_bf16 v[188:191], v[240:243], v[28:31], 0
    ds_read_b64_tr_b16 v[28:29], v11 offset:0
    ds_read_b64_tr_b16 v[30:31], v11 offset:512
    v_cvt_pk_bf16_f32 v136, v16, v17
    v_cvt_pk_bf16_f32 v144, v18, v19
    v_mfma_f32_16x16x32_bf16 v[192:195], v[240:243], v[40:43], 0
    ds_read_b64_tr_b16 v[40:41], v10 offset:8192
    ds_read_b64_tr_b16 v[42:43], v10 offset:8704
    v_add_f32 v20, v160, v164
    v_add_f32 v21, v161, v165
    v_sub_f32 v22, v160, v164
    v_sub_f32 v23, v161, v165
    v_mfma_f32_16x16x32_bf16 v[196:199], v[240:243], v[44:47], 0
    ds_read_b64_tr_b16 v[44:45], v11 offset:8192
    ds_read_b64_tr_b16 v[46:47], v11 offset:8704
    v_cvt_pk_bf16_f32 v137, v20, v21
    v_cvt_pk_bf16_f32 v145, v22, v23
    v_mfma_f32_16x16x32_bf16 v[200:203], v[240:243], v[56:59], 0
    ds_read_b64_tr_b16 v[56:57], v10 offset:16384
    ds_read_b64_tr_b16 v[58:59], v10 offset:16896
    v_add_f32 v16, v168, v172
    v_add_f32 v17, v169, v173
    v_sub_f32 v18, v168, v172
    v_sub_f32 v19, v169, v173
    v_mfma_f32_16x16x32_bf16 v[204:207], v[240:243], v[60:63], 0
    ds_read_b64_tr_b16 v[60:61], v11 offset:16384
    ds_read_b64_tr_b16 v[62:63], v11 offset:16896
    v_cvt_pk_bf16_f32 v138, v16, v17
    v_cvt_pk_bf16_f32 v146, v18, v19
    v_mfma_f32_16x16x32_bf16 v[208:211], v[240:243], v[72:75], 0
    ds_read_b64_tr_b16 v[72:73], v10 offset:24576
    ds_read_b64_tr_b16 v[74:75], v10 offset:25088
    v_add_f32 v20, v176, v180
    v_add_f32 v21, v177, v181
    v_sub_f32 v22, v176, v180
    v_sub_f32 v23, v177, v181
    v_mfma_f32_16x16x32_bf16 v[212:215], v[240:243], v[76:79], 0
    ds_read_b64_tr_b16 v[76:77], v11 offset:24576
    ds_read_b64_tr_b16 v[78:79], v11 offset:25088
    v_cvt_pk_bf16_f32 v139, v20, v21
    v_cvt_pk_bf16_f32 v147, v22, v23
    s_mov_b32 s47, 12845056
    buffer_store_dwordx4 v[136:139], v12, s[36:39], s47 offen sc1
    s_mov_b32 s47, 12850176
    buffer_store_dwordx4 v[144:147], v12, s[36:39], s47 offen sc1
    v_mfma_f32_16x16x32_bf16 v[184:187], v[244:247], v[32:35], v[184:187]
    ds_read_b64_tr_b16 v[32:33], v10 offset:4096
    ds_read_b64_tr_b16 v[34:35], v10 offset:4608
    v_add_f32 v16, v154, v158
    v_add_f32 v17, v155, v159
    v_sub_f32 v18, v154, v158
    v_sub_f32 v19, v155, v159
    v_mfma_f32_16x16x32_bf16 v[188:191], v[244:247], v[36:39], v[188:191]
    ds_read_b64_tr_b16 v[36:37], v11 offset:4096
    ds_read_b64_tr_b16 v[38:39], v11 offset:4608
    v_cvt_pk_bf16_f32 v140, v16, v17
    v_cvt_pk_bf16_f32 v148, v18, v19
    v_mfma_f32_16x16x32_bf16 v[192:195], v[244:247], v[48:51], v[192:195]
    ds_read_b64_tr_b16 v[48:49], v10 offset:12288
    ds_read_b64_tr_b16 v[50:51], v10 offset:12800
    v_add_f32 v20, v162, v166
    v_add_f32 v21, v163, v167
    v_sub_f32 v22, v162, v166
    v_sub_f32 v23, v163, v167
    v_mfma_f32_16x16x32_bf16 v[196:199], v[244:247], v[52:55], v[196:199]
    ds_read_b64_tr_b16 v[52:53], v11 offset:12288
    ds_read_b64_tr_b16 v[54:55], v11 offset:12800
    v_cvt_pk_bf16_f32 v141, v20, v21
    v_cvt_pk_bf16_f32 v149, v22, v23
    v_mfma_f32_16x16x32_bf16 v[200:203], v[244:247], v[64:67], v[200:203]
    ds_read_b64_tr_b16 v[64:65], v10 offset:20480
    ds_read_b64_tr_b16 v[66:67], v10 offset:20992
    v_add_f32 v16, v170, v174
    v_add_f32 v17, v171, v175
    v_sub_f32 v18, v170, v174
    v_sub_f32 v19, v171, v175
    v_mfma_f32_16x16x32_bf16 v[204:207], v[244:247], v[68:71], v[204:207]
    ds_read_b64_tr_b16 v[68:69], v11 offset:20480
    ds_read_b64_tr_b16 v[70:71], v11 offset:20992
    v_cvt_pk_bf16_f32 v142, v16, v17
    v_cvt_pk_bf16_f32 v150, v18, v19
    v_mfma_f32_16x16x32_bf16 v[208:211], v[244:247], v[80:83], v[208:211]
    ds_read_b64_tr_b16 v[80:81], v10 offset:28672
    ds_read_b64_tr_b16 v[82:83], v10 offset:29184
    v_add_f32 v20, v178, v182
    v_add_f32 v21, v179, v183
    v_sub_f32 v22, v178, v182
    v_sub_f32 v23, v179, v183
    v_mfma_f32_16x16x32_bf16 v[212:215], v[244:247], v[84:87], v[212:215]
    ds_read_b64_tr_b16 v[84:85], v11 offset:28672
    ds_read_b64_tr_b16 v[86:87], v11 offset:29184
    v_cvt_pk_bf16_f32 v143, v20, v21
    v_cvt_pk_bf16_f32 v151, v22, v23
    s_mov_b32 s47, 12926976
    buffer_store_dwordx4 v[140:143], v12, s[36:39], s47 offen sc1
    s_mov_b32 s47, 12932096
    buffer_store_dwordx4 v[148:151], v12, s[36:39], s47 offen sc1
    s_waitcnt lgkmcnt(15)
    v_mfma_f32_16x16x32_bf16 v[152:155], v[248:251], v[24:27], 0
    v_add_f32 v16, v184, v188
    v_add_f32 v17, v185, v189
    v_sub_f32 v18, v184, v188
    v_sub_f32 v19, v185, v189
    v_mfma_f32_16x16x32_bf16 v[156:159], v[248:251], v[28:31], 0
    v_cvt_pk_bf16_f32 v136, v16, v17
    v_cvt_pk_bf16_f32 v144, v18, v19
    v_mfma_f32_16x16x32_bf16 v[160:163], v[248:251], v[40:43], 0
    v_add_f32 v20, v192, v196
    v_add_f32 v21, v193, v197
    v_sub_f32 v22, v192, v196
    v_sub_f32 v23, v193, v197
    v_mfma_f32_16x16x32_bf16 v[164:167], v[248:251], v[44:47], 0
    v_cvt_pk_bf16_f32 v137, v20, v21
    v_cvt_pk_bf16_f32 v145, v22, v23
    v_mfma_f32_16x16x32_bf16 v[168:171], v[248:251], v[56:59], 0
    v_add_f32 v16, v200, v204
    v_add_f32 v17, v201, v205
    v_sub_f32 v18, v200, v204
    v_sub_f32 v19, v201, v205
    v_mfma_f32_16x16x32_bf16 v[172:175], v[248:251], v[60:63], 0
    v_cvt_pk_bf16_f32 v138, v16, v17
    v_cvt_pk_bf16_f32 v146, v18, v19
    v_mfma_f32_16x16x32_bf16 v[176:179], v[248:251], v[72:75], 0
    v_add_f32 v20, v208, v212
    v_add_f32 v21, v209, v213
    v_sub_f32 v22, v208, v212
    v_sub_f32 v23, v209, v213
    v_mfma_f32_16x16x32_bf16 v[180:183], v[248:251], v[76:79], 0
    v_cvt_pk_bf16_f32 v139, v20, v21
    v_cvt_pk_bf16_f32 v147, v22, v23
    s_mov_b32 s47, 13500416
    buffer_store_dwordx4 v[136:139], v12, s[36:39], s47 offen sc1
    s_mov_b32 s47, 13505536
    buffer_store_dwordx4 v[144:147], v12, s[36:39], s47 offen sc1
    s_waitcnt lgkmcnt(0)
    v_mfma_f32_16x16x32_bf16 v[152:155], v[252:255], v[32:35], v[152:155]
    v_add_f32 v16, v186, v190
    v_add_f32 v17, v187, v191
    v_sub_f32 v18, v186, v190
    v_sub_f32 v19, v187, v191
    v_mfma_f32_16x16x32_bf16 v[156:159], v[252:255], v[36:39], v[156:159]
    v_cvt_pk_bf16_f32 v140, v16, v17
    v_cvt_pk_bf16_f32 v148, v18, v19
    v_mfma_f32_16x16x32_bf16 v[160:163], v[252:255], v[48:51], v[160:163]
    v_add_f32 v20, v194, v198
    v_add_f32 v21, v195, v199
    v_sub_f32 v22, v194, v198
    v_sub_f32 v23, v195, v199
    v_mfma_f32_16x16x32_bf16 v[164:167], v[252:255], v[52:55], v[164:167]
    v_cvt_pk_bf16_f32 v141, v20, v21
    v_cvt_pk_bf16_f32 v149, v22, v23
    v_mfma_f32_16x16x32_bf16 v[168:171], v[252:255], v[64:67], v[168:171]
    v_add_f32 v16, v202, v206
    v_add_f32 v17, v203, v207
    v_sub_f32 v18, v202, v206
    v_sub_f32 v19, v203, v207
    v_mfma_f32_16x16x32_bf16 v[172:175], v[252:255], v[68:71], v[172:175]
    v_cvt_pk_bf16_f32 v142, v16, v17
    v_cvt_pk_bf16_f32 v150, v18, v19
    v_mfma_f32_16x16x32_bf16 v[176:179], v[252:255], v[80:83], v[176:179]
    v_add_f32 v20, v210, v214
    v_add_f32 v21, v211, v215
    v_sub_f32 v22, v210, v214
    v_sub_f32 v23, v211, v215
    v_mfma_f32_16x16x32_bf16 v[180:183], v[252:255], v[84:87], v[180:183]
    v_cvt_pk_bf16_f32 v143, v20, v21
    v_cvt_pk_bf16_f32 v151, v22, v23
    s_mov_b32 s47, 13582336
    buffer_store_dwordx4 v[140:143], v12, s[36:39], s47 offen sc1
    s_mov_b32 s47, 13587456
    buffer_store_dwordx4 v[148:151], v12, s[36:39], s47 offen sc1
    s_nop 7
    v_add_f32 v16, v152, v156
    v_add_f32 v17, v153, v157
    v_sub_f32 v18, v152, v156
    v_sub_f32 v19, v153, v157
    v_cvt_pk_bf16_f32 v136, v16, v17
    v_cvt_pk_bf16_f32 v144, v18, v19
    v_add_f32 v20, v160, v164
    v_add_f32 v21, v161, v165
    v_sub_f32 v22, v160, v164
    v_sub_f32 v23, v161, v165
    v_cvt_pk_bf16_f32 v137, v20, v21
    v_cvt_pk_bf16_f32 v145, v22, v23
    v_add_f32 v16, v168, v172
    v_add_f32 v17, v169, v173
    v_sub_f32 v18, v168, v172
    v_sub_f32 v19, v169, v173
    v_cvt_pk_bf16_f32 v138, v16, v17
    v_cvt_pk_bf16_f32 v146, v18, v19
    v_add_f32 v20, v176, v180
    v_add_f32 v21, v177, v181
    v_sub_f32 v22, v176, v180
    v_sub_f32 v23, v177, v181
    v_cvt_pk_bf16_f32 v139, v20, v21
    v_cvt_pk_bf16_f32 v147, v22, v23
    s_mov_b32 s47, 11534336
    buffer_store_dwordx4 v[136:139], v13, s[36:39], s47 offen sc1
    s_mov_b32 s47, 11539456
    buffer_store_dwordx4 v[144:147], v13, s[36:39], s47 offen sc1
    v_add_f32 v16, v154, v158
    v_add_f32 v17, v155, v159
    v_sub_f32 v18, v154, v158
    v_sub_f32 v19, v155, v159
    v_cvt_pk_bf16_f32 v140, v16, v17
    v_cvt_pk_bf16_f32 v148, v18, v19
    v_add_f32 v20, v162, v166
    v_add_f32 v21, v163, v167
    v_sub_f32 v22, v162, v166
    v_sub_f32 v23, v163, v167
    v_cvt_pk_bf16_f32 v141, v20, v21
    v_cvt_pk_bf16_f32 v149, v22, v23
    v_add_f32 v16, v170, v174
    v_add_f32 v17, v171, v175
    v_sub_f32 v18, v170, v174
    v_sub_f32 v19, v171, v175
    v_cvt_pk_bf16_f32 v142, v16, v17
    v_cvt_pk_bf16_f32 v150, v18, v19
    v_add_f32 v20, v178, v182
    v_add_f32 v21, v179, v183
    v_sub_f32 v22, v178, v182
    v_sub_f32 v23, v179, v183
    v_cvt_pk_bf16_f32 v143, v20, v21
    v_cvt_pk_bf16_f32 v151, v22, v23
    s_mov_b32 s47, 11616256
    buffer_store_dwordx4 v[140:143], v13, s[36:39], s47 offen sc1
    s_mov_b32 s47, 11621376
    buffer_store_dwordx4 v[148:151], v13, s[36:39], s47 offen sc1
    s_waitcnt vmcnt(0)
    s_barrier
    s_cmp_lg_u32 s46, 0
    s_cbranch_scc1 L_gf_87
    s_lshl_b32 s47, s2, 7
    s_add_u32 s47, s47, 14712832
    v_mov_b32 v8, s47
    v_mov_b32 v9, s26
    s_mov_b64 exec, 1
    buffer_store_dword v9, v8, s[36:39], 0 offen sc1
    s_mov_b64 exec, -1
    v_mov_b32 v12, 131072
    v_mov_b32 v8, 0
    v_mov_b32 v9, 0
    v_mov_b32 v10, 0
    v_mov_b32 v11, 0
    ds_write_b128 v12, v[8:11] offset:32256
    ds_write_b128 v12, v[8:11] offset:32272
    ds_write_b128 v12, v[8:11] offset:32288
    ds_write_b128 v12, v[8:11] offset:32304
    ds_write_b128 v12, v[8:11] offset:32320
    ds_write_b128 v12, v[8:11] offset:32336
    ds_write_b128 v12, v[8:11] offset:32352
    ds_write_b128 v12, v[8:11] offset:32368
    ds_write_b128 v12, v[8:11] offset:32384
    ds_write_b128 v12, v[8:11] offset:32400
    v_and_b32 v17, 31, v1
    v_lshl_add_u32 v17, v17, 3, s44
    v_lshlrev_b32 v17, 7, v17
    s_mov_b32 s47, 0
    s_mov_b32 s48, 14778368
L_poll_89:
    buffer_load_dword v18, v17, s[36:39], s48 offen sc1
    s_waitcnt vmcnt(0)
    v_subrev_u32 v18, s26, v18
    v_cmp_lt_u32 vcc, 15, v18
    s_cbranch_vccz L_polld_90
    s_add_u32 s47, s47, 1
    s_cmp_lt_u32 s47, 0x100000
    s_cbranch_scc1 L_poll_89
L_polld_90:
L_mok_88:
    v_readfirstlane_b32 s47, v18
    v_mov_b32 v19, 131072
    s_nop 0
    v_cmp_ne_u32 vcc, s47, v18
    s_cmp_eq_u64 vcc, 0
    s_cselect_b32 s47, 1, 0
    s_mov_b64 exec, 1
    v_mov_b32 v17, s47
    ds_write_b32 v19, v17 offset:32280
    s_mov_b64 exec, -1
    s_mov_b64 exec, 1
    v_mov_b32 v18, s26
    ds_write_b32 v19, v18 offset:32284
    s_mov_b64 exec, -1
    s_waitcnt lgkmcnt(0)
L_gf_87:
    s_barrier
    v_mov_b32 v8, 131072
    ds_read_b32 v9, v8 offset:32280
    s_waitcnt lgkmcnt(0)
    v_readfirstlane_b32 s27, v9
    s_cmp_lt_u32 s46, 4
    s_cbranch_scc1 L_sw_91
L_sw_91:
    s_cmp_lt_u32 s46, 4
    s_cbranch_scc1 L_spl_4
    s_branch L_high_6
L_end_1:
    s_endpgm
.section .rodata,"a"
.p2align 6
.amdhsa_kernel concat_heads__sliding_block__spectral_fnet__prompt_kernel
  .amdhsa_next_free_vgpr 256
  .amdhsa_next_free_sgpr 102
  .amdhsa_accum_offset 256
  .amdhsa_group_segment_fixed_size 0
  .amdhsa_kernarg_size 88
  .amdhsa_user_sgpr_count 2
  .amdhsa_user_sgpr_kernarg_segment_ptr 1
  .amdhsa_system_sgpr_workgroup_id_x 1
.end_amdhsa_kernel
```
